```python
import torch

def _softmax(x, axis=-1):
    return torch.softmax(x, dim=axis)
def _gelu(x):
    return torch.nn.functional.gelu(x, approximate="tanh")
def _silu(x):
    return torch.nn.functional.silu(x)
def _sigmoid(x):
    return torch.sigmoid(x)
def _layernorm(x, axis=-1, eps=1e-5):
    m = x.mean(dim=axis, keepdim=True)
    v = x.var(dim=axis, keepdim=True, unbiased=False)
    return (x - m) / torch.sqrt(v + eps)
def _scatter_add(tgt, idx, src, axis=0):
    return tgt.clone().index_add_(axis, idx, src)
def _segment_sum(src, seg, n):
    out = torch.zeros((n,) + src.shape[1:], dtype=src.dtype)
    return out.index_add_(0, seg, src)
def _pad(x, pw):
    flat = tuple(v for pair in reversed(pw) for v in pair)
    return torch.nn.functional.pad(x, flat)

kernel_name = 'interleave_layers__compressed_kv_cla__glu_gated_geglu__decode'

def setup_inputs():

    _w = (lambda a: (lambda t: t.to(torch.bfloat16) if t.is_floating_point() else t)(torch.as_tensor(a)))
    def _A_setup():
        B, H, Sq, Sk, D, M = 1, 32, 1, 8192, 128, 640
        Dc = 4 * D
        return {
            "x": _w((lambda *s: torch.randn(*s, dtype=torch.bfloat16) * 0.05)(B, Sq, M)),
            "c_kv": _w((lambda *s: torch.randn(*s, dtype=torch.bfloat16) * 0.8)(B, Sk, Dc)),
            "w_q": _w((lambda *s: torch.randn(*s, dtype=torch.bfloat16) * 1.6)(M, H, D) * (M ** -0.5)),
            "w_uk": _w((lambda *s: torch.randn(*s, dtype=torch.bfloat16) * 1.6)(Dc, H, D) * (Dc ** -0.5)),
            "w_uv": _w((lambda *s: torch.randn(*s, dtype=torch.bfloat16) * 0.8)(Dc, H, D) * (Dc ** -0.5)),
            "w_o": _w((lambda *s: torch.randn(*s, dtype=torch.bfloat16) * 0.8)(H, D, M) * ((H * D) ** -0.5)),
        }
    _A_in = _A_setup()

    def _B_setup():
        B, S, Dm, Df = 1, 1, 640, 1728
        return {
            "x": _w((lambda *s: torch.randn(*s, dtype=torch.bfloat16) * 0.05)(B, S, Dm)),
            "w_gate": _w((lambda *s: torch.randn(*s, dtype=torch.bfloat16) * 0.4)(Dm, Df) * (Dm ** -0.5)),
            "w_up": _w((lambda *s: torch.randn(*s, dtype=torch.bfloat16) * 0.4)(Dm, Df) * (Dm ** -0.5)),
            "w_down": _w((lambda *s: torch.randn(*s, dtype=torch.bfloat16) * 0.4)(Df, Dm) * (Df ** -0.5)),
        }
    _B_in = _B_setup()

    return {
        "A_x": _A_in["x"],
        "A_c_kv": _A_in["c_kv"],
        "A_w_q": _A_in["w_q"],
        "A_w_uk": _A_in["w_uk"],
        "A_w_uv": _A_in["w_uv"],
        "A_w_o": _A_in["w_o"],
        "B_x": _B_in["x"],
        "B_w_gate": _B_in["w_gate"],
        "B_w_up": _B_in["w_up"],
        "B_w_down": _B_in["w_down"],
    }

def reference(A_x, A_c_kv, A_w_q, A_w_uk, A_w_uv, A_w_o, B_x, B_w_gate, B_w_up, B_w_down):
    def _A_ref(x, c_kv, w_q, w_uk, w_uv, w_o):
        B, Sq, M = x.shape[0], x.shape[1], x.shape[2]
        Sk = c_kv.shape[1]
        H, D = w_q.shape[1], w_q.shape[2]
        q = torch.einsum("bqm,mhd->bhqd", x, w_q)
        k = torch.einsum("bkc,chd->bhkd", c_kv, w_uk)
        v = torch.einsum("bkc,chd->bhkd", c_kv, w_uv)
        scores = torch.einsum("bhqd,bhkd->bhqk", q, k) * (D ** -0.5)
        off = Sk - Sq
        qi = torch.arange(Sq)[:, None]
        kj = torch.arange(Sk)[None, :]
        cmask = kj <= (qi + off)
        scores = torch.where(cmask[None, None], scores, -1e9)
        p = _softmax(scores, axis=-1)
        ctx = torch.einsum("bhqk,bhkd->bhqd", p, v)
        return torch.einsum("bhqd,hdm->bqm", ctx, w_o)

    def _B_ref(x, w_gate, w_up, w_down):
        g = torch.einsum("bsd,df->bsf", x, w_gate)
        u = torch.einsum("bsd,df->bsf", x, w_up)
        h = _gelu(g) * u
        return torch.einsum("bsf,fd->bsd", h, w_down)

    x = A_x
    x = x + _A_ref(_layernorm(x, axis=-1), A_c_kv, A_w_q, A_w_uk, A_w_uv, A_w_o)
    x = x + _B_ref(_layernorm(x, axis=-1), B_w_gate, B_w_up, B_w_down)
    x = x + _A_ref(_layernorm(x, axis=-1), A_c_kv, A_w_q, A_w_uk, A_w_uv, A_w_o)
    x = x + _B_ref(_layernorm(x, axis=-1), B_w_gate, B_w_up, B_w_down)
    return x
```

```asm
; @launch grid=(256,1,1) block=(512,1,1) lds=155648
.amdgcn_target "amdgcn-amd-amdhsa--gfx950"
.text
.globl interleave_layers__compressed_kv_cla__glu_gated_geglu__decode_kernel
.p2align 8
.type interleave_layers__compressed_kv_cla__glu_gated_geglu__decode_kernel,@function
interleave_layers__compressed_kv_cla__glu_gated_geglu__decode_kernel:
  s_cmp_ge_u32 s2, 256
  s_cbranch_scc1 QUIT
  s_load_dwordx2 s[4:5], s[0:1], 96
  s_mov_b32 s6, 268435456
  s_mov_b32 s7, 0x20000
  s_load_dwordx2 s[8:9], s[0:1], 88
  s_mov_b32 s10, 256
  s_mov_b32 s11, 0x20000
  s_load_dwordx2 s[24:25], s[0:1], 0
  s_mov_b32 s26, 1280
  s_mov_b32 s27, 0x20000
  s_load_dwordx2 s[28:29], s[0:1], 80
  s_mov_b32 s30, 1280
  s_mov_b32 s31, 0x20000
  v_lshrrev_b32 v12, 6, v0
  v_and_b32 v1, 63, v0
  v_readfirstlane_b32 s3, v12
  v_and_b32 v2, 15, v0
  v_bfe_u32 v3, v0, 4, 2
  s_mov_b32 s40, 0x40000
  s_mov_b32 s51, s3
  v_and_b32 v28, 7, v0
  v_lshlrev_b32 v28, 2, v28
  v_mov_b32 v29, 0
  s_mov_b32 s46, 0x3f803f80
  s_mov_b64 s[62:63], -1
  s_mov_b32 s41, 0
  s_mov_b32 s42, 0
  s_mov_b32 s43, 0
  s_mov_b32 s47, 0
  v_and_b32 v12, 1, v0
  v_cmp_eq_u32 vcc, 1, v12
  v_mov_b32 v13, 0xffff
  v_mov_b32 v14, 0xffff0000
  v_cndmask_b32 v13, v13, v14, vcc
  v_bfe_u32 v12, v0, 1, 2
  v_cmp_eq_u32 vcc, 0, v12
  s_nop 1
  v_cndmask_b32 v4, 0, v13, vcc
  v_and_b32 v8, s46, v4
  v_cmp_eq_u32 vcc, 1, v12
  s_nop 1
  v_cndmask_b32 v5, 0, v13, vcc
  v_and_b32 v9, s46, v5
  v_cmp_eq_u32 vcc, 2, v12
  s_nop 1
  v_cndmask_b32 v6, 0, v13, vcc
  v_and_b32 v10, s46, v6
  v_cmp_eq_u32 vcc, 3, v12
  s_nop 1
  v_cndmask_b32 v7, 0, v13, vcc
  v_and_b32 v11, s46, v7
  s_cmp_lt_u32 s2, 64
  s_cbranch_scc1 ROLE_Q
  s_cmp_lt_u32 s2, 192
  s_cbranch_scc1 ROLE_A
  s_cmp_lt_u32 s2, 224
  s_cbranch_scc1 ROLE_O
  s_branch ROLE_M
BAIL:
QUIT:
  s_endpgm
ROLE_Q:
  s_load_dwordx2 s[12:13], s[0:1], 16
  s_mov_b32 s14, 5242880
  s_mov_b32 s15, 0x20000
  s_load_dwordx2 s[16:17], s[0:1], 24
  s_mov_b32 s18, 4194304
  s_mov_b32 s19, 0x20000
  s_and_b32 s37, s2, 7
  s_lshl_b32 s37, s37, 3
  s_lshr_b32 s38, s2, 3
  s_add_u32 s37, s37, s38
  s_lshr_b32 s48, s37, 1
  s_and_b32 s49, s37, 1
  v_lshrrev_b32 v12, 3, v2
  v_lshl_add_u32 v37, v12, 2, v3
  s_lshl_b32 s38, s3, 8
  v_mul_u32_u24 v32, 1280, v3
  v_lshl_add_u32 v32, v2, 4, v32
  v_add_u32 v32, s38, v32
  v_and_b32 v12, 1, v3
  v_lshlrev_b32 v12, 4, v12
  v_lshl_add_u32 v33, v2, 5, v12
  s_lshl_b32 s38, s3, 9
  v_add_u32 v33, s38, v33
  s_mul_i32 s38, s3, 320
  v_mul_u32_u24 v34, 4, v37
  v_add_u32 v34, s38, v34
  v_mul_u32_u24 v35, 20, v1
  v_add_u32 v35, 32768, v35
  v_and_b32 v13, 7, v2
  v_lshl_add_u32 v12, v13, 5, v12
  v_lshrrev_b32 v13, 1, v3
  v_mul_u32_u24 v13, 528, v13
  s_mul_i32 s38, s3, 1056
  v_add3_u32 v36, v12, v13, s38
  s_lshl_b32 s50, s49, 15
  s_lshl_b32 s38, s48, 10
  s_add_u32 s50, s50, s38
  s_add_u32 s50, s50, 2129920
  s_waitcnt lgkmcnt(0)
  v_lshlrev_b32 v20, 4, v1
  v_lshrrev_b32 v12, 1, v33
  buffer_load_dwordx2 v[46:47], v12, s[24:27], 0 offen
  buffer_load_dwordx4 v[68:71], v20, s[24:27], 0 offen
  v_lshlrev_b32 v21, 2, v1
  buffer_load_dword v67, v21, s[24:27], 0 offen offset:1024
  s_mul_i32 s38, s3, 655360
  s_lshl_b32 s39, s48, 8
  s_lshl_b32 s58, s49, 7
  s_add_u32 s39, s39, s58
  s_add_u32 s38, s38, s39
  v_mul_u32_u24 v38, 8192, v37
  v_and_b32 v12, 7, v2
  v_and_b32 v13, 0, v12
  v_add_u32 v12, v12, v13
  v_lshl_add_u32 v38, v12, 4, v38
  v_add_u32 v38, s38, v38
  s_lshl_b32 s38, s3, 19
  s_add_u32 s38, s38, s39
  v_lshrrev_b32 v12, 3, v1
  v_and_b32 v13, 7, v1
  v_xor_b32 v13, v13, v12
  v_and_b32 v14, 0, v13
  v_add_u32 v13, v13, v14
  v_lshlrev_b32 v12, 13, v12
  v_lshl_add_u32 v12, v13, 4, v12
  v_add_u32 v72, s38, v12
  v_lshrrev_b32 v12, 2, v2
  v_and_b32 v13, 3, v2
  v_lshl_add_u32 v12, v12, 3, v13
  v_lshlrev_b32 v14, 1, v3
  v_xor_b32 v13, v13, v14
  v_lshlrev_b32 v13, 4, v13
  v_lshl_add_u32 v12, v12, 7, v13
  s_lshl_b32 s58, s3, 13
  s_add_u32 s58, s58, 65536
  v_add_u32 v73, s58, v12
  v_mov_b32 v42, 0
  s_mov_b64 s[32:33], s[4:5]
  s_mov_b32 s34, s6
  s_mov_b32 s35, 0x20000
  s_cmp_ge_u32 s3, 4
  s_cbranch_scc1 Q_LD
Q_RA:
  v_and_b32 v12, 7, v1
  v_mul_u32_u24 v12, 1056, v12
  v_lshrrev_b32 v13, 3, v1
  s_lshl_b32 s38, s3, 3
  v_add_u32 v13, s38, v13
  v_lshl_add_u32 v39, v13, 2, v12
  v_lshlrev_b32 v40, 1, v13
  v_lshlrev_b32 v41, 5, v3
  v_and_b32 v12, 1, v2
  v_lshlrev_b32 v12, 6, v12
  v_lshl_add_u32 v12, v3, 4, v12
  s_lshl_b32 s38, s3, 7
  v_add_u32 v42, s38, v12
  v_mov_b32 v43, 0
  s_cmp_ge_u32 s3, 4
  s_cbranch_scc1 Q_GO
  s_mov_b32 s36, 49
  s_mov_b64 s[44:45], 0
  s_mov_b32 s59, s3
  s_mov_b32 s51, 0
  s_branch DRYNQ
DRYDQ:
Q_LD:
  s_mov_b32 s38, 0
  buffer_load_dwordx4 v[144:147], v38, s[12:15], s38 offen nt
  s_mov_b32 s38, 65536
  buffer_load_dwordx4 v[148:151], v38, s[12:15], s38 offen nt
  s_mov_b32 s38, 131072
  buffer_load_dwordx4 v[152:155], v38, s[12:15], s38 offen nt
  s_mov_b32 s38, 196608
  buffer_load_dwordx4 v[156:159], v38, s[12:15], s38 offen nt
  s_mov_b32 s38, 262144
  buffer_load_dwordx4 v[160:163], v38, s[12:15], s38 offen nt
  s_mov_b32 s38, 327680
  buffer_load_dwordx4 v[164:167], v38, s[12:15], s38 offen nt
  s_mov_b32 s38, 393216
  buffer_load_dwordx4 v[168:171], v38, s[12:15], s38 offen nt
  s_mov_b32 s38, 458752
  buffer_load_dwordx4 v[172:175], v38, s[12:15], s38 offen nt
  s_mov_b32 s38, 524288
  buffer_load_dwordx4 v[176:179], v38, s[12:15], s38 offen nt
  s_mov_b32 s38, 589824
  buffer_load_dwordx4 v[180:183], v38, s[12:15], s38 offen nt
  s_add_u32 m0, s58, 0
  s_mov_b32 s38, 0
  buffer_load_dwordx4 v72, s[16:19], s38 offen nt lds
  s_add_u32 m0, s58, 1024
  s_mov_b32 s38, 65536
  buffer_load_dwordx4 v72, s[16:19], s38 offen nt lds
  s_add_u32 m0, s58, 2048
  s_mov_b32 s38, 131072
  buffer_load_dwordx4 v72, s[16:19], s38 offen nt lds
  s_add_u32 m0, s58, 3072
  s_mov_b32 s38, 196608
  buffer_load_dwordx4 v72, s[16:19], s38 offen nt lds
  s_add_u32 m0, s58, 4096
  s_mov_b32 s38, 262144
  buffer_load_dwordx4 v72, s[16:19], s38 offen nt lds
  s_add_u32 m0, s58, 5120
  s_mov_b32 s38, 327680
  buffer_load_dwordx4 v72, s[16:19], s38 offen nt lds
  s_add_u32 m0, s58, 6144
  s_mov_b32 s38, 393216
  buffer_load_dwordx4 v72, s[16:19], s38 offen nt lds
  s_add_u32 m0, s58, 7168
  s_mov_b32 s38, 458752
  buffer_load_dwordx4 v72, s[16:19], s38 offen nt lds
  s_cmp_ge_u32 s3, 4
  s_cbranch_scc1 Q_RA
Q_GO:
  s_waitcnt vmcnt(18)
  s_cmp_lg_u32 s3, 0
  s_cbranch_scc1 F_1
  buffer_load_dword v29, v28, s[8:11], 0 offen
F_1:
  v_mov_b32 v84, 0
  v_mov_b32 v85, 0
  v_dot2c_f32_bf16 v84, s46, v67
  v_dot2c_f32_bf16 v85, v67, v67
  v_dot2c_f32_bf16 v84, s46, v68
  v_dot2c_f32_bf16 v85, v68, v68
  v_dot2c_f32_bf16 v84, s46, v69
  v_dot2c_f32_bf16 v85, v69, v69
  v_dot2c_f32_bf16 v84, s46, v70
  v_dot2c_f32_bf16 v85, v70, v70
  v_dot2c_f32_bf16 v84, s46, v71
  v_dot2c_f32_bf16 v85, v71, v71
  s_nop 1
  v_add_f32_dpp v84, v84, v84 quad_perm:[1,0,3,2] row_mask:0xf bank_mask:0xf
  v_add_f32_dpp v85, v85, v85 quad_perm:[1,0,3,2] row_mask:0xf bank_mask:0xf
  s_nop 0
  v_add_f32_dpp v84, v84, v84 quad_perm:[2,3,0,1] row_mask:0xf bank_mask:0xf
  v_add_f32_dpp v85, v85, v85 quad_perm:[2,3,0,1] row_mask:0xf bank_mask:0xf
  s_nop 0
  v_add_f32_dpp v84, v84, v84 row_half_mirror row_mask:0xf bank_mask:0xf
  v_add_f32_dpp v85, v85, v85 row_half_mirror row_mask:0xf bank_mask:0xf
  s_nop 0
  v_add_f32_dpp v84, v84, v84 row_mirror row_mask:0xf bank_mask:0xf
  v_add_f32_dpp v85, v85, v85 row_mirror row_mask:0xf bank_mask:0xf
  v_mov_b32 v86, v84
  v_mov_b32 v87, v85
  s_nop 0
  v_permlane16_swap_b32 v84, v86
  v_permlane16_swap_b32 v85, v87
  v_add_f32 v84, v84, v86
  v_add_f32 v85, v85, v87
  v_mov_b32 v86, v84
  v_mov_b32 v87, v85
  s_nop 0
  v_permlane32_swap_b32 v84, v86
  v_permlane32_swap_b32 v85, v87
  v_add_f32 v84, v84, v86
  v_add_f32 v85, v85, v87
  v_mul_f32 v84, 986500301, v84
  v_mul_f32 v85, 986500301, v85
  v_fma_f32 v85, -v84, v84, v85
  v_max_f32 v85, 0, v85
  v_cvt_pk_bf16_f32 v44, v84, v84
  v_and_b32 v44, 0xffff0000, v44
  v_cvt_pk_bf16_f32 v85, v85, v85
  v_and_b32 v85, 0xffff0000, v85
  v_add_f32 v85, 925353388, v85
  v_cvt_pk_bf16_f32 v85, v85, v85
  v_and_b32 v85, 0xffff0000, v85
  v_sqrt_f32 v85, v85
  s_nop 0
  v_cvt_pk_bf16_f32 v85, v85, v85
  v_and_b32 v85, 0xffff0000, v85
  v_rcp_f32 v45, v85
  v_lshlrev_b32 v48, 16, v46
  v_and_b32 v49, 0xffff0000, v46
  v_lshlrev_b32 v50, 16, v47
  v_and_b32 v51, 0xffff0000, v47
  s_mov_b32 s52, 118294644
  s_mov_b32 s53, 5
  s_cmp_lg_u32 s37, 0
  s_cbranch_scc1 C_2
  s_mov_b32 s52, 252512372
  s_mov_b32 s53, 10420
C_2:
  s_mov_b32 s43, 6430720
Q_LOOP:
  s_and_b32 s36, s52, 0xfff
  s_lshr_b64 s[52:53], s[52:53], 12
  s_bitcmp1_b32 s36, 1
  s_cselect_b64 s[44:45], -1, 0
  s_bitcmp1_b32 s36, 9
  s_cselect_b32 s41, 4194304, 0
  s_add_u32 s41, s41, 2238464
  s_bitcmp1_b32 s36, 10
  s_cselect_b32 s42, 4194304, 0
  s_add_u32 s42, s42, s50
  s_bitcmp1_b32 s36, 9
  s_cbranch_scc0 C_3
  s_mov_b64 s[32:33], s[28:29]
  s_mov_b32 s34, s30
  s_mov_b32 s35, 0x20000
  s_mov_b32 s43, 0
  s_cmp_ge_u32 s3, 5
  s_cbranch_scc1 BAIL
C_3:
SEG_4:
  s_cmp_ge_u32 s51, 5
  s_cbranch_scc1 Q_B1
  s_bitcmp1_b32 s36, 0
  s_cbranch_scc0 PG_5
  s_add_u32 s38, s41, 0
  buffer_load_dwordx4 v[116:119], v32, s[4:7], s38 offen sc1
  s_add_u32 s38, s41, 5120
  buffer_load_dwordx4 v[120:123], v32, s[4:7], s38 offen sc1
  s_add_u32 s38, s41, 10240
  buffer_load_dwordx4 v[124:127], v32, s[4:7], s38 offen sc1
  s_add_u32 s38, s41, 15360
  buffer_load_dwordx4 v[128:131], v32, s[4:7], s38 offen sc1
  s_add_u32 s38, s41, 20480
  buffer_load_dwordx4 v[132:135], v32, s[4:7], s38 offen sc1
  s_add_u32 s38, s41, 25600
  buffer_load_dwordx4 v[136:139], v32, s[4:7], s38 offen sc1
  s_add_u32 s38, s41, 30720
  buffer_load_dwordx4 v[140:143], v32, s[4:7], s38 offen sc1
  s_bitcmp1_b32 s36, 1
  s_cbranch_scc0 NW_7
WT_6:
  s_waitcnt vmcnt(0)
NW_7:
  v_mfma_f32_16x16x32_bf16 v[52:55], v[8:11], v[116:119], 0
  v_mfma_f32_16x16x32_bf16 v[52:55], v[8:11], v[120:123], v[52:55]
  v_max_u32 v12, v119, v123
  v_mfma_f32_16x16x32_bf16 v[52:55], v[8:11], v[124:127], v[52:55]
  v_max3_u32 v12, v12, v127, v131
  v_mfma_f32_16x16x32_bf16 v[52:55], v[8:11], v[128:131], v[52:55]
  v_mfma_f32_16x16x32_bf16 v[52:55], v[8:11], v[132:135], v[52:55]
  v_max3_u32 v12, v12, v135, v139
  v_mfma_f32_16x16x32_bf16 v[52:55], v[8:11], v[136:139], v[52:55]
  v_max_u32 v12, v12, v143
  v_mfma_f32_16x16x32_bf16 v[52:55], v[8:11], v[140:143], v[52:55]
  v_cmp_eq_u32 vcc, -1, v12
  s_and_b64 vcc, vcc, s[44:45]
  s_cbranch_vccz OK_8
  s_sub_u32 s40, s40, 1
  s_cbranch_scc1 BAIL
  v_cmp_eq_u32 vcc, -1, v119
  s_cbranch_vccz SK_9
  s_add_u32 s38, s41, 0
  buffer_load_dwordx4 v[116:119], v32, s[4:7], s38 offen sc1
SK_9:
  v_cmp_eq_u32 vcc, -1, v123
  s_cbranch_vccz SK_10
  s_add_u32 s38, s41, 5120
  buffer_load_dwordx4 v[120:123], v32, s[4:7], s38 offen sc1
SK_10:
  v_cmp_eq_u32 vcc, -1, v127
  s_cbranch_vccz SK_11
  s_add_u32 s38, s41, 10240
  buffer_load_dwordx4 v[124:127], v32, s[4:7], s38 offen sc1
SK_11:
  v_cmp_eq_u32 vcc, -1, v131
  s_cbranch_vccz SK_12
  s_add_u32 s38, s41, 15360
  buffer_load_dwordx4 v[128:131], v32, s[4:7], s38 offen sc1
SK_12:
  v_cmp_eq_u32 vcc, -1, v135
  s_cbranch_vccz SK_13
  s_add_u32 s38, s41, 20480
  buffer_load_dwordx4 v[132:135], v32, s[4:7], s38 offen sc1
SK_13:
  v_cmp_eq_u32 vcc, -1, v139
  s_cbranch_vccz SK_14
  s_add_u32 s38, s41, 25600
  buffer_load_dwordx4 v[136:139], v32, s[4:7], s38 offen sc1
SK_14:
  v_cmp_eq_u32 vcc, -1, v143
  s_cbranch_vccz SK_15
  s_add_u32 s38, s41, 30720
  buffer_load_dwordx4 v[140:143], v32, s[4:7], s38 offen sc1
SK_15:
  s_branch WT_6
OK_8:
PG_5:
  s_cbranch_execz DRYXQ
SEG_16:
  s_bfe_u32 s38, s36, 131076
  s_cmp_eq_u32 s38, 0
  s_cbranch_scc1 X_20
  s_cmp_eq_u32 s38, 1
  s_cbranch_scc1 X_17
  s_cmp_eq_u32 s38, 2
  s_cbranch_scc1 X_18
  v_sub_f32 v52, v48, v44
  v_cvt_pk_bf16_f32 v52, v52, v52
  v_and_b32 v52, 0xffff0000, v52
  v_mul_f32 v52, v52, v45
  v_sub_f32 v53, v49, v44
  v_cvt_pk_bf16_f32 v53, v53, v53
  v_and_b32 v53, 0xffff0000, v53
  v_mul_f32 v53, v53, v45
  v_sub_f32 v54, v50, v44
  v_cvt_pk_bf16_f32 v54, v54, v54
  v_and_b32 v54, 0xffff0000, v54
  v_mul_f32 v54, v54, v45
  v_sub_f32 v55, v51, v44
  v_cvt_pk_bf16_f32 v55, v55, v55
  v_and_b32 v55, 0xffff0000, v55
  v_mul_f32 v55, v55, v45
  s_branch X_20
X_18:
  v_mov_b32 v52, v48
  v_mov_b32 v53, v49
  v_mov_b32 v54, v50
  v_mov_b32 v55, v51
  s_branch X_20
X_17:
  v_mov_b32 v52, 1.0
  v_mov_b32 v53, 1.0
  v_mov_b32 v54, 1.0
  v_mov_b32 v55, 1.0
X_20:
  s_nop 0
  v_cvt_pk_bf16_f32 v12, v52, v52
  v_cvt_pk_bf16_f32 v13, v53, v53
  v_cvt_pk_bf16_f32 v14, v54, v54
  v_cvt_pk_bf16_f32 v15, v55, v55
  ds_write_b128 v33, v[12:15] offset:0
  v_cvt_pk_bf16_f32 v16, v52, v53
  v_cvt_pk_bf16_f32 v17, v54, v55
  v_lshrrev_b32 v18, 1, v33
  ds_write_b64 v18, v[16:17] offset:32768
  s_bitcmp1_b32 s36, 3
  s_cbranch_scc0 Q_B1
  v_mov_b32 v18, v16
  v_mov_b32 v19, v17
  s_nop 0
  v_permlane16_swap_b32 v16, v18
  v_permlane16_swap_b32 v17, v19
  v_min_u32 v19, -2, v19
  s_and_b64 exec, s[62:63], 0xffff
  buffer_store_dwordx4 v[16:19], v32, s[32:35], s43 offen sc1
  s_mov_b64 exec, s[62:63]
  s_bitcmp1_b32 s36, 9
  s_cbranch_scc1 BAIL
Q_B1:
  s_cbranch_execz DRYXQ
  s_waitcnt lgkmcnt(0)
  s_barrier
SEG_23:
  ds_read2_b32 v[56:57], v34 offset0:0 offset1:8
  ds_read2_b32 v[58:59], v34 offset0:16 offset1:24
  ds_read2_b32 v[60:61], v34 offset0:32 offset1:40
  ds_read2_b32 v[62:63], v34 offset0:48 offset1:56
  ds_read2_b32 v[64:65], v34 offset0:64 offset1:72
  s_bitcmp1_b32 s36, 11
  s_cbranch_scc0 W_24
  s_waitcnt vmcnt(0)
  ds_read_b128 v[184:187], v73 offset:0
  ds_read_b128 v[200:203], v73 offset:4096
  v_xor_b32 v76, 16, v73
  ds_read_b128 v[188:191], v76 offset:0
  ds_read_b128 v[204:207], v76 offset:4096
  v_xor_b32 v76, 64, v73
  ds_read_b128 v[192:195], v76 offset:512
  ds_read_b128 v[208:211], v76 offset:4608
  v_xor_b32 v76, 80, v73
  ds_read_b128 v[196:199], v76 offset:512
  ds_read_b128 v[212:215], v76 offset:4608
  s_cmp_lg_u32 s3, 0
  s_cbranch_scc1 F_21
F_22:
  v_cmp_ne_u32 vcc, 1, v29
  s_and_b64 vcc, vcc, 255
  s_cbranch_vccz F_21
  s_sub_u32 s40, s40, 1
  s_cbranch_scc1 BAIL
  s_sleep 8
  buffer_load_dword v29, v28, s[8:11], 0 offen sc1
  s_waitcnt vmcnt(0)
  s_branch F_22
F_21:
W_24:
  s_cmp_eq_u32 s51, 7
  s_cbranch_scc1 S7_25
  s_waitcnt lgkmcnt(0)
  v_and_b32 v76, v56, v4
  v_and_b32 v77, v56, v5
  v_and_b32 v78, v56, v6
  v_and_b32 v79, v56, v7
  s_nop 1
  v_mfma_f32_16x16x32_bf16 v[88:91], v[76:79], v[144:147], 0
  v_and_b32 v80, v57, v4
  v_and_b32 v81, v57, v5
  v_and_b32 v82, v57, v6
  v_and_b32 v83, v57, v7
  s_nop 1
  v_mfma_f32_16x16x32_bf16 v[88:91], v[80:83], v[148:151], v[88:91]
  v_and_b32 v76, v58, v4
  v_and_b32 v77, v58, v5
  v_and_b32 v78, v58, v6
  v_and_b32 v79, v58, v7
  s_nop 1
  v_mfma_f32_16x16x32_bf16 v[88:91], v[76:79], v[152:155], v[88:91]
  v_and_b32 v80, v59, v4
  v_and_b32 v81, v59, v5
  v_and_b32 v82, v59, v6
  v_and_b32 v83, v59, v7
  s_nop 1
  v_mfma_f32_16x16x32_bf16 v[88:91], v[80:83], v[156:159], v[88:91]
  v_and_b32 v76, v60, v4
  v_and_b32 v77, v60, v5
  v_and_b32 v78, v60, v6
  v_and_b32 v79, v60, v7
  s_nop 1
  v_mfma_f32_16x16x32_bf16 v[88:91], v[76:79], v[160:163], v[88:91]
  s_cbranch_execz DRYXQ
SEG_27:
  v_and_b32 v80, v61, v4
  v_and_b32 v81, v61, v5
  v_and_b32 v82, v61, v6
  v_and_b32 v83, v61, v7
  s_nop 1
  v_mfma_f32_16x16x32_bf16 v[88:91], v[80:83], v[164:167], v[88:91]
  v_and_b32 v76, v62, v4
  v_and_b32 v77, v62, v5
  v_and_b32 v78, v62, v6
  v_and_b32 v79, v62, v7
  s_nop 1
  v_mfma_f32_16x16x32_bf16 v[88:91], v[76:79], v[168:171], v[88:91]
  v_and_b32 v80, v63, v4
  v_and_b32 v81, v63, v5
  v_and_b32 v82, v63, v6
  v_and_b32 v83, v63, v7
  s_nop 1
  v_mfma_f32_16x16x32_bf16 v[88:91], v[80:83], v[172:175], v[88:91]
  v_and_b32 v76, v64, v4
  v_and_b32 v77, v64, v5
  v_and_b32 v78, v64, v6
  v_and_b32 v79, v64, v7
  s_nop 1
  v_mfma_f32_16x16x32_bf16 v[88:91], v[76:79], v[176:179], v[88:91]
  v_and_b32 v80, v65, v4
  v_and_b32 v81, v65, v5
  v_and_b32 v82, v65, v6
  v_and_b32 v83, v65, v7
  s_nop 1
  v_mfma_f32_16x16x32_bf16 v[88:91], v[80:83], v[180:183], v[88:91]
  s_branch SE_26
S7_25:
SEG_28:
  s_setprio 3
  ds_read2_b32 v[66:67], v35 offset0:0 offset1:1
  ds_read2_b32 v[68:69], v35 offset0:2 offset1:3
  ds_read_b32 v70, v35 offset:16
  s_waitcnt lgkmcnt(0)
  v_mov_b32 v84, 0
  v_mov_b32 v85, 0
  v_dot2c_f32_bf16 v84, s46, v66
  v_dot2c_f32_bf16 v85, v66, v66
  v_dot2c_f32_bf16 v84, s46, v67
  v_dot2c_f32_bf16 v85, v67, v67
  v_dot2c_f32_bf16 v84, s46, v68
  v_dot2c_f32_bf16 v85, v68, v68
  v_dot2c_f32_bf16 v84, s46, v69
  v_dot2c_f32_bf16 v85, v69, v69
  v_dot2c_f32_bf16 v84, s46, v70
  v_dot2c_f32_bf16 v85, v70, v70
  v_and_b32 v76, v56, v4
  v_and_b32 v77, v56, v5
  v_add_f32_dpp v84, v84, v84 quad_perm:[1,0,3,2] row_mask:0xf bank_mask:0xf
  v_and_b32 v78, v56, v6
  v_add_f32_dpp v85, v85, v85 quad_perm:[1,0,3,2] row_mask:0xf bank_mask:0xf
  v_and_b32 v79, v56, v7
  s_nop 1
  v_mfma_f32_16x16x32_bf16 v[88:91], v[76:79], v[144:147], 0
  v_add_f32_dpp v84, v84, v84 quad_perm:[2,3,0,1] row_mask:0xf bank_mask:0xf
  v_and_b32 v80, v57, v4
  v_add_f32_dpp v85, v85, v85 quad_perm:[2,3,0,1] row_mask:0xf bank_mask:0xf
  v_and_b32 v81, v57, v5
  v_and_b32 v82, v57, v6
  v_add_f32_dpp v84, v84, v84 row_half_mirror row_mask:0xf bank_mask:0xf
  v_and_b32 v83, v57, v7
  v_add_f32_dpp v85, v85, v85 row_half_mirror row_mask:0xf bank_mask:0xf
  s_nop 0
  v_mfma_f32_16x16x32_bf16 v[88:91], v[80:83], v[148:151], v[88:91]
  v_add_f32_dpp v84, v84, v84 row_mirror row_mask:0xf bank_mask:0xf
  v_and_b32 v76, v58, v4
  v_and_b32 v77, v58, v5
  v_add_f32_dpp v85, v85, v85 row_mirror row_mask:0xf bank_mask:0xf
  v_and_b32 v78, v58, v6
  v_mov_b32 v86, v84
  v_and_b32 v79, v58, v7
  s_nop 1
  v_mfma_f32_16x16x32_bf16 v[88:91], v[76:79], v[152:155], v[88:91]
  v_mov_b32 v87, v85
  v_and_b32 v80, v59, v4
  v_permlane16_swap_b32 v84, v86
  v_and_b32 v81, v59, v5
  v_and_b32 v82, v59, v6
  v_permlane16_swap_b32 v85, v87
  v_and_b32 v83, v59, v7
  v_add_f32 v84, v84, v86
  s_nop 0
  v_mfma_f32_16x16x32_bf16 v[88:91], v[80:83], v[156:159], v[88:91]
  v_add_f32 v85, v85, v87
  v_and_b32 v76, v60, v4
  v_and_b32 v77, v60, v5
  s_cbranch_execz DRYXQ
SEG_29:
  v_mov_b32 v86, v84
  v_and_b32 v78, v60, v6
  v_mov_b32 v87, v85
  v_and_b32 v79, v60, v7
  s_nop 1
  v_mfma_f32_16x16x32_bf16 v[88:91], v[76:79], v[160:163], v[88:91]
  v_permlane32_swap_b32 v84, v86
  v_and_b32 v80, v61, v4
  v_permlane32_swap_b32 v85, v87
  v_and_b32 v81, v61, v5
  v_and_b32 v82, v61, v6
  v_add_f32 v84, v84, v86
  v_and_b32 v83, v61, v7
  v_add_f32 v85, v85, v87
  s_nop 0
  v_mfma_f32_16x16x32_bf16 v[88:91], v[80:83], v[164:167], v[88:91]
  v_mul_f32 v84, 986500301, v84
  v_and_b32 v76, v62, v4
  v_and_b32 v77, v62, v5
  v_mul_f32 v85, 986500301, v85
  v_and_b32 v78, v62, v6
  v_fma_f32 v85, -v84, v84, v85
  v_and_b32 v79, v62, v7
  s_nop 1
  v_mfma_f32_16x16x32_bf16 v[88:91], v[76:79], v[168:171], v[88:91]
  v_max_f32 v85, 0, v85
  v_and_b32 v80, v63, v4
  v_cvt_pk_bf16_f32 v44, v84, v84
  v_and_b32 v81, v63, v5
  v_and_b32 v82, v63, v6
  v_and_b32 v44, 0xffff0000, v44
  v_and_b32 v83, v63, v7
  v_cvt_pk_bf16_f32 v85, v85, v85
  s_nop 0
  v_mfma_f32_16x16x32_bf16 v[88:91], v[80:83], v[172:175], v[88:91]
  v_and_b32 v85, 0xffff0000, v85
  v_and_b32 v76, v64, v4
  v_and_b32 v77, v64, v5
  v_add_f32 v85, 925353388, v85
  v_and_b32 v78, v64, v6
  v_cvt_pk_bf16_f32 v85, v85, v85
  v_and_b32 v79, v64, v7
  s_nop 1
  v_mfma_f32_16x16x32_bf16 v[88:91], v[76:79], v[176:179], v[88:91]
  v_and_b32 v85, 0xffff0000, v85
  v_and_b32 v80, v65, v4
  v_sqrt_f32 v85, v85
  v_and_b32 v81, v65, v5
  v_and_b32 v82, v65, v6
  v_cvt_pk_bf16_f32 v85, v85, v85
  v_and_b32 v83, v65, v7
  v_and_b32 v85, 0xffff0000, v85
  s_nop 0
  v_mfma_f32_16x16x32_bf16 v[88:91], v[80:83], v[180:183], v[88:91]
  v_rcp_f32 v45, v85
  s_setprio 0
  s_bitcmp1_b32 s36, 6
  s_cbranch_scc0 W_30
  v_mov_b32 v44, 0
  v_mov_b32 v45, 1.0
W_30:
  v_mov_b32 v84, 11136
  ds_write_b64 v84, v[44:45]
  s_cbranch_execz DRYXQ
SE_26:
  s_and_b32 exec_lo, s62, 0x00ff00ff
  s_and_b32 exec_hi, s62, 0xff00ff00
  s_nop 4
  ds_write_b128 v36, v[88:91] offset:2560
  s_mov_b64 exec, s[62:63]
  v_mov_b32 v84, 11136
  s_cbranch_execz DRYXQ
  s_waitcnt lgkmcnt(0)
  s_barrier
SEG_31:
  ds_read_b64 v[44:45], v84
  ds_read_b32 v12, v39 offset:2560
  ds_read_b32 v13, v39 offset:3088
  s_waitcnt lgkmcnt(0)
  v_add_f32 v12, v12, v13
  s_nop 1
  v_add_f32_dpp v12, v12, v12 quad_perm:[1,0,3,2] row_mask:0xf bank_mask:0xf
  s_nop 1
  v_add_f32_dpp v12, v12, v12 quad_perm:[2,3,0,1] row_mask:0xf bank_mask:0xf
  s_nop 1
  v_add_f32_dpp v12, v12, v12 row_half_mirror row_mask:0xf bank_mask:0xf
  s_bitcmp1_b32 s36, 7
  s_cbranch_scc0 C_32
  v_mov_b32 v43, v12
C_32:
  v_fma_f32 v12, -v44, v43, v12
  v_mul_f32 v13, 1040356334, v45
  v_mul_f32 v12, v12, v13
  v_cvt_pk_bf16_f32 v12, v12, v12
  ds_write_b16 v40, v12 offset:11008
  s_cbranch_execz DRYXQ
  s_waitcnt lgkmcnt(0)
  s_barrier
SEG_33:
  ds_read_b128 v[92:95], v41 offset:11008
  ds_read_b128 v[96:99], v41 offset:11024
  s_waitcnt lgkmcnt(0)
  v_mfma_f32_16x16x32_bf16 v[100:103], v[184:187], v[92:95], 0
  v_mfma_f32_16x16x32_bf16 v[104:107], v[192:195], v[92:95], 0
  v_mfma_f32_16x16x32_bf16 v[108:111], v[200:203], v[92:95], 0
  v_mfma_f32_16x16x32_bf16 v[112:115], v[208:211], v[92:95], 0
  v_mfma_f32_16x16x32_bf16 v[100:103], v[188:191], v[96:99], v[100:103]
  v_mfma_f32_16x16x32_bf16 v[104:107], v[196:199], v[96:99], v[104:107]
  v_mfma_f32_16x16x32_bf16 v[108:111], v[204:207], v[96:99], v[108:111]
  v_mfma_f32_16x16x32_bf16 v[112:115], v[212:215], v[96:99], v[112:115]
  v_and_b32 v20, 1, v2
  v_cmp_eq_u32 vcc, 1, v20
  s_nop 2
  v_cvt_pk_bf16_f32 v12, v100, v101
  v_cvt_pk_bf16_f32 v13, v102, v103
  v_cvt_pk_bf16_f32 v14, v104, v105
  v_cvt_pk_bf16_f32 v15, v106, v107
  v_cvt_pk_bf16_f32 v16, v108, v109
  v_cvt_pk_bf16_f32 v17, v110, v111
  v_cvt_pk_bf16_f32 v18, v112, v113
  v_cvt_pk_bf16_f32 v19, v114, v115
  v_cndmask_b32 v12, v12, v16, vcc
  v_cndmask_b32 v13, v13, v17, vcc
  v_cndmask_b32 v14, v14, v18, vcc
  v_cndmask_b32 v15, v15, v19, vcc
  v_min_u32 v15, -2, v15
  s_bitcmp1_b32 s36, 2
  s_cbranch_scc0 C_34
  s_and_b32 exec_lo, s62, 0x00030003
  s_and_b32 exec_hi, s62, 0x00030003
  buffer_store_dwordx4 v[12:15], v42, s[4:7], s42 offen sc1
  s_mov_b64 exec, s[62:63]
C_34:
  s_cbranch_execz DRYXQ
  s_bitcmp1_b32 s36, 8
  s_cbranch_scc1 BAIL
  s_branch Q_LOOP
DRYXQ:
  s_add_u32 s59, s59, 4
DRYNQ:
  s_mov_b64 exec, 0
  s_mov_b64 s[62:63], 0
  s_cmp_eq_u32 s59, 0
  s_cbranch_scc1 SEG_4
  s_cmp_eq_u32 s59, 1
  s_cbranch_scc1 SEG_16
  s_cmp_eq_u32 s59, 2
  s_cbranch_scc1 SEG_23
  s_cmp_eq_u32 s59, 3
  s_cbranch_scc1 SEG_27
  s_cmp_eq_u32 s59, 4
  s_cbranch_scc1 SEG_28
  s_cmp_eq_u32 s59, 5
  s_cbranch_scc1 SEG_29
  s_cmp_eq_u32 s59, 6
  s_cbranch_scc1 SEG_31
  s_cmp_eq_u32 s59, 7
  s_cbranch_scc1 SEG_33
  s_mov_b64 exec, -1
  s_mov_b64 s[62:63], -1
  s_mov_b32 s51, s3
  s_branch DRYDQ
ROLE_M:
  s_cmp_lt_u32 s2, 232
  s_cbranch_scc1 P_35
  s_cmp_ge_u32 s3, 5
  s_cbranch_scc1 P_37
  s_sub_u32 s37, s2, 224
  s_and_b32 s39, s37, 7
  s_lshl_b32 s39, s39, 10
  s_add_u32 s39, s39, 384
  s_lshr_b32 s38, s37, 3
  s_cmp_eq_u32 s3, 2
  s_cbranch_scc1 P_36
  s_load_dwordx4 s[64:67], s[0:1], 24
  s_mov_b32 s34, 4194304
  s_mov_b32 s35, 0x20000
  s_lshl_b32 s38, s38, 1
  s_and_b32 s58, s3, 1
  s_add_u32 s38, s38, s58
  s_waitcnt lgkmcnt(0)
  s_cmp_ge_u32 s3, 3
  s_cselect_b32 s32, s66, s64
  s_cselect_b32 s33, s67, s65
  s_lshl_b32 s38, s38, 19
  s_add_u32 s38, s38, s39
  v_lshlrev_b32 v12, 13, v1
  buffer_load_dword v24, v12, s[32:35], s38 offen
  s_branch P_37
P_36:
  s_load_dwordx2 s[32:33], s[0:1], 16
  s_mov_b32 s34, 5242880
  s_mov_b32 s35, 0x20000
  s_add_u32 s38, s38, 6
  s_lshl_b32 s38, s38, 16
  s_add_u32 s38, s38, s39
  v_lshrrev_b32 v12, 3, v1
  v_mul_u32_u24 v12, 80, v12
  v_and_b32 v13, 7, v1
  v_add_u32 v12, v12, v13
  v_lshlrev_b32 v12, 13, v12
  s_waitcnt lgkmcnt(0)
  buffer_load_dword v24, v12, s[32:35], s38 offen
P_37:
P_35:
  s_cmp_ge_u32 s2, 251
  s_cbranch_scc1 QUIT
  s_load_dwordx2 s[12:13], s[0:1], 56
  s_mov_b32 s14, 2211840
  s_mov_b32 s15, 0x20000
  s_load_dwordx2 s[16:17], s[0:1], 64
  s_mov_b32 s18, 2211840
  s_mov_b32 s19, 0x20000
  s_load_dwordx2 s[20:21], s[0:1], 72
  s_mov_b32 s22, 2211840
  s_mov_b32 s23, 0x20000
  s_sub_u32 s37, s2, 224
  v_lshrrev_b32 v12, 3, v2
  v_lshl_add_u32 v37, v12, 2, v3
  s_lshl_b32 s38, s3, 8
  v_mul_u32_u24 v32, 1280, v3
  v_lshl_add_u32 v32, v2, 4, v32
  v_add_u32 v32, s38, v32
  v_and_b32 v12, 1, v3
  v_lshlrev_b32 v12, 4, v12
  v_lshl_add_u32 v33, v2, 5, v12
  s_lshl_b32 s38, s3, 9
  v_add_u32 v33, s38, v33
  s_mul_i32 s38, s3, 320
  v_mul_u32_u24 v34, 4, v37
  v_add_u32 v34, s38, v34
  v_mul_u32_u24 v35, 20, v1
  v_add_u32 v35, 32768, v35
  v_and_b32 v13, 7, v2
  v_lshl_add_u32 v12, v13, 5, v12
  v_lshrrev_b32 v13, 1, v3
  v_mul_u32_u24 v13, 528, v13
  s_mul_i32 s38, s3, 1056
  v_add3_u32 v36, v12, v13, s38
  v_lshlrev_b32 v12, 4, v3
  v_lshl_add_u32 v12, v2, 5, v12
  s_mul_i32 s38, s3, 2576
  v_add_u32 v40, s38, v12
  v_and_b32 v12, 1, v0
  v_mul_u32_u24 v12, 10304, v12
  v_lshrrev_b32 v13, 1, v0
  v_lshl_add_u32 v41, v13, 4, v12
  v_lshrrev_b32 v13, 2, v0
  v_lshlrev_b32 v42, 4, v13
  s_mul_i32 s50, s37, 1280
  s_add_u32 s50, s50, 2238464
  s_waitcnt lgkmcnt(0)
  s_cmp_ge_u32 s37, 8
  s_cbranch_scc1 C_38
  s_lshl_b32 s38, s37, 3
  s_add_u32 s38, s38, s3
  s_mul_i32 s38, s38, 3072
  s_add_u32 s38, s38, 2097152
  s_add_u32 s39, s38, 4194304
  v_lshlrev_b32 v13, 4, v1
  v_mov_b32 v16, -1
  v_mov_b32 v17, -1
  v_mov_b32 v18, -1
  v_mov_b32 v19, -1
  buffer_store_dwordx4 v[16:19], v13, s[4:7], s38 offen offset:0 sc1
  buffer_store_dwordx4 v[16:19], v13, s[4:7], s38 offen offset:1024 sc1
  buffer_store_dwordx4 v[16:19], v13, s[4:7], s38 offen offset:2048 sc1
  buffer_store_dwordx4 v[16:19], v13, s[4:7], s39 offen offset:0 sc1
  buffer_store_dwordx4 v[16:19], v13, s[4:7], s39 offen offset:1024 sc1
  buffer_store_dwordx4 v[16:19], v13, s[4:7], s39 offen offset:2048 sc1
C_38:
  v_mov_b32 v132, 0
  v_mov_b32 v133, 0
  v_mov_b32 v134, 0
  v_mov_b32 v135, 0
  s_mul_i32 s38, s3, 276480
  s_lshl_b32 s39, s37, 7
  s_add_u32 s38, s38, s39
  v_mul_u32_u24 v38, 3456, v37
  v_and_b32 v12, 7, v2
  v_lshl_add_u32 v38, v12, 4, v38
  v_add_u32 v38, s38, v38
  s_lshl_b32 s38, s37, 6
  s_lshl_b32 s39, s3, 3
  s_add_u32 s38, s38, s39
  s_mul_i32 s38, s38, 1280
  v_mul_u32_u24 v12, 1280, v3
  v_lshl_add_u32 v12, v2, 4, v12
  v_add_u32 v46, s38, v12
  v_and_b32 v12, 3, v1
  v_mul_u32_u24 v12, 2112, v12
  v_bfe_u32 v13, v1, 2, 1
  v_lshl_add_u32 v12, v13, 8, v12
  v_bfe_u32 v13, v1, 3, 1
  v_lshl_add_u32 v13, v13, 2, v3
  v_lshl_add_u32 v12, v13, 2, v12
  s_lshl_b32 s38, s3, 5
  v_add_u32 v39, s38, v12
  v_mov_b32 v43, 0
  v_bfe_u32 v13, v1, 2, 1
  v_cmp_eq_u32 s[60:61], 1, v13
  s_mov_b64 s[32:33], s[24:25]
  s_mov_b32 s34, s26
  s_mov_b32 s35, 0x20000
  s_mov_b32 s36, 1
  s_mov_b64 s[44:45], 0
  s_mov_b32 s59, s3
  s_mov_b32 s51, 0
  s_branch DRYNM
DRYDM:
  s_cmp_ge_u32 s37, 8
  s_cbranch_scc1 C_39
  s_waitcnt vmcnt(0)
  s_barrier
  s_cmp_lg_u32 s3, 0
  s_cbranch_scc1 F_40
  s_lshl_b32 s38, s37, 2
  v_mov_b32 v12, s38
  v_mov_b32 v13, 1
  s_mov_b64 exec, 1
  buffer_store_dword v13, v12, s[8:11], 0 offen sc1
  s_mov_b64 exec, -1
F_40:
  s_cmp_ge_u32 s3, 5
  s_cbranch_scc1 P_42
  s_sub_u32 s37, s2, 224
  s_and_b32 s39, s37, 7
  s_lshl_b32 s39, s39, 10
  s_add_u32 s39, s39, 384
  s_lshr_b32 s38, s37, 3
  s_cmp_eq_u32 s3, 2
  s_cbranch_scc1 P_41
  s_load_dwordx4 s[64:67], s[0:1], 24
  s_mov_b32 s34, 4194304
  s_mov_b32 s35, 0x20000
  s_lshl_b32 s38, s38, 1
  s_and_b32 s58, s3, 1
  s_add_u32 s38, s38, s58
  s_waitcnt lgkmcnt(0)
  s_cmp_ge_u32 s3, 3
  s_cselect_b32 s32, s66, s64
  s_cselect_b32 s33, s67, s65
  s_lshl_b32 s38, s38, 19
  s_add_u32 s38, s38, s39
  v_lshlrev_b32 v12, 13, v1
  buffer_load_dword v24, v12, s[32:35], s38 offen
  s_branch P_42
P_41:
  s_load_dwordx2 s[32:33], s[0:1], 16
  s_mov_b32 s34, 5242880
  s_mov_b32 s35, 0x20000
  s_add_u32 s38, s38, 6
  s_lshl_b32 s38, s38, 16
  s_add_u32 s38, s38, s39
  v_lshrrev_b32 v12, 3, v1
  v_mul_u32_u24 v12, 80, v12
  v_and_b32 v13, 7, v1
  v_add_u32 v12, v12, v13
  v_lshlrev_b32 v12, 13, v12
  s_waitcnt lgkmcnt(0)
  buffer_load_dword v24, v12, s[32:35], s38 offen
P_42:
  s_mov_b64 s[32:33], s[24:25]
  s_mov_b32 s34, s26
  s_mov_b32 s35, 0x20000
C_39:
  s_cmp_lg_u32 s3, 0
  s_cbranch_scc1 F_45
  buffer_load_dword v29, v28, s[8:11], 0 offen
F_45:
  s_cmp_lg_u32 s3, 0
  s_cbranch_scc1 R_43
  s_waitcnt vmcnt(0)
  s_cmp_lg_u32 s3, 0
  s_cbranch_scc1 F_46
F_47:
  v_cmp_ne_u32 vcc, 1, v29
  s_and_b64 vcc, vcc, 255
  s_cbranch_vccz F_46
  s_sub_u32 s40, s40, 1
  s_cbranch_scc1 BAIL
  s_sleep 8
  buffer_load_dword v29, v28, s[8:11], 0 offen sc1
  s_waitcnt vmcnt(0)
  s_branch F_47
F_46:
  s_and_b32 s38, s37, 1
  s_lshl_b32 s38, s38, 13
  s_add_u32 s38, s38, 2113536
  v_lshlrev_b32 v12, 7, v1
R_44:
  buffer_load_dword v13, v12, s[4:7], s38 offen sc1
  s_waitcnt vmcnt(0)
  v_cmp_eq_u32 vcc, -1, v13
  s_cbranch_vccz R_43
  s_sub_u32 s40, s40, 1
  s_cbranch_scc1 BAIL
  s_sleep 8
  s_branch R_44
R_43:
  s_barrier
  s_mov_b32 s38, 0
  buffer_load_dwordx4 v[136:139], v38, s[12:15], s38 offen nt
  buffer_load_dwordx4 v[176:179], v38, s[16:19], s38 offen nt
  s_mov_b32 s38, 27648
  buffer_load_dwordx4 v[140:143], v38, s[12:15], s38 offen nt
  buffer_load_dwordx4 v[180:183], v38, s[16:19], s38 offen nt
  s_mov_b32 s38, 55296
  buffer_load_dwordx4 v[144:147], v38, s[12:15], s38 offen nt
  buffer_load_dwordx4 v[184:187], v38, s[16:19], s38 offen nt
  s_mov_b32 s38, 82944
  buffer_load_dwordx4 v[148:151], v38, s[12:15], s38 offen nt
  buffer_load_dwordx4 v[188:191], v38, s[16:19], s38 offen nt
  s_mov_b32 s38, 110592
  buffer_load_dwordx4 v[152:155], v38, s[12:15], s38 offen nt
  buffer_load_dwordx4 v[192:195], v38, s[16:19], s38 offen nt
  s_mov_b32 s38, 138240
  buffer_load_dwordx4 v[156:159], v38, s[12:15], s38 offen nt
  buffer_load_dwordx4 v[196:199], v38, s[16:19], s38 offen nt
  s_mov_b32 s38, 165888
  buffer_load_dwordx4 v[160:163], v38, s[12:15], s38 offen nt
  buffer_load_dwordx4 v[200:203], v38, s[16:19], s38 offen nt
  s_mov_b32 s38, 193536
  buffer_load_dwordx4 v[164:167], v38, s[12:15], s38 offen nt
  buffer_load_dwordx4 v[204:207], v38, s[16:19], s38 offen nt
  s_mov_b32 s38, 221184
  buffer_load_dwordx4 v[168:171], v38, s[12:15], s38 offen nt
  buffer_load_dwordx4 v[208:211], v38, s[16:19], s38 offen nt
  s_mov_b32 s38, 248832
  buffer_load_dwordx4 v[172:175], v38, s[12:15], s38 offen nt
  buffer_load_dwordx4 v[212:215], v38, s[16:19], s38 offen nt
  s_mov_b32 s38, 0
  buffer_load_dwordx4 v[216:219], v46, s[20:23], s38 offen offset:0 nt
  s_mov_b32 s38, 0
  buffer_load_dwordx4 v[220:223], v46, s[20:23], s38 offen offset:256 nt
  s_mov_b32 s38, 0
  buffer_load_dwordx4 v[224:227], v46, s[20:23], s38 offen offset:512 nt
  s_mov_b32 s38, 0
  buffer_load_dwordx4 v[228:231], v46, s[20:23], s38 offen offset:768 nt
  s_mov_b32 s38, 0
  buffer_load_dwordx4 v[232:235], v46, s[20:23], s38 offen offset:1024 nt
  s_mov_b32 s38, 5120
  buffer_load_dwordx4 v[236:239], v46, s[20:23], s38 offen offset:0 nt
  s_mov_b32 s38, 5120
  buffer_load_dwordx4 v[240:243], v46, s[20:23], s38 offen offset:256 nt
  s_mov_b32 s38, 5120
  buffer_load_dwordx4 v[244:247], v46, s[20:23], s38 offen offset:512 nt
  s_mov_b32 s38, 5120
  buffer_load_dwordx4 v[248:251], v46, s[20:23], s38 offen offset:768 nt
  s_mov_b32 s38, 5120
  buffer_load_dwordx4 v[252:255], v46, s[20:23], s38 offen offset:1024 nt
  s_mov_b32 s52, 117471440
  s_mov_b32 s53, 3
  s_cmp_lg_u32 s37, 0
  s_cbranch_scc1 C_48
  s_mov_b32 s52, 251721936
  s_mov_b32 s53, 3
C_48:
M_LOOP:
  s_and_b32 s36, s52, 0xfff
  s_lshr_b64 s[52:53], s[52:53], 12
  s_bitcmp1_b32 s36, 1
  s_cselect_b64 s[44:45], -1, 0
  s_bitcmp1_b32 s36, 9
  s_cselect_b32 s41, 4194304, 0
  s_add_u32 s41, s41, 2195456
  s_bitcmp1_b32 s36, 9
  s_cselect_b32 s43, 4194304, 0
  s_add_u32 s43, s43, 2273024
  s_bitcmp1_b32 s36, 9
  s_cselect_b32 s42, 4194304, 0
  s_add_u32 s42, s42, s50
  s_bitcmp1_b32 s36, 9
  s_cbranch_scc0 C_49
  s_mov_b64 s[32:33], s[4:5]
  s_mov_b32 s34, s6
  s_mov_b32 s35, 0x20000
  s_mov_b32 s47, 6430720
C_49:
SEG_50:
  s_cmp_ge_u32 s51, 5
  s_cbranch_scc1 M_B1
  s_bitcmp1_b32 s36, 0
  s_cbranch_scc0 PG_51
  s_add_u32 s38, s41, 0
  buffer_load_dwordx4 v[100:103], v32, s[4:7], s38 offen sc1
  s_add_u32 s38, s41, 5120
  buffer_load_dwordx4 v[104:107], v32, s[4:7], s38 offen sc1
  s_add_u32 s38, s41, 10240
  buffer_load_dwordx4 v[108:111], v32, s[4:7], s38 offen sc1
  s_add_u32 s38, s41, 15360
  buffer_load_dwordx4 v[112:115], v32, s[4:7], s38 offen sc1
  s_add_u32 s38, s41, 20480
  buffer_load_dwordx4 v[116:119], v32, s[4:7], s38 offen sc1
  s_add_u32 s38, s41, 25600
  buffer_load_dwordx4 v[120:123], v32, s[4:7], s38 offen sc1
  s_add_u32 s38, s41, 30720
  buffer_load_dwordx4 v[124:127], v32, s[4:7], s38 offen sc1
  s_add_u32 s38, s41, 35840
  buffer_load_dwordx4 v[128:131], v32, s[4:7], s38 offen sc1
  s_and_b64 exec, s[62:63], 0xffff
  buffer_load_dwordx4 v[132:135], v32, s[32:35], s47 offen sc1
  s_mov_b64 exec, s[62:63]
  s_bitcmp1_b32 s36, 1
  s_cbranch_scc0 NW_53
WT_52:
  s_waitcnt vmcnt(0)
NW_53:
  v_mfma_f32_16x16x32_bf16 v[48:51], v[8:11], v[100:103], 0
  v_mfma_f32_16x16x32_bf16 v[48:51], v[8:11], v[104:107], v[48:51]
  v_max_u32 v12, v103, v107
  v_mfma_f32_16x16x32_bf16 v[48:51], v[8:11], v[108:111], v[48:51]
  v_max3_u32 v12, v12, v111, v115
  v_mfma_f32_16x16x32_bf16 v[48:51], v[8:11], v[112:115], v[48:51]
  v_mfma_f32_16x16x32_bf16 v[48:51], v[8:11], v[116:119], v[48:51]
  v_max3_u32 v12, v12, v119, v123
  v_mfma_f32_16x16x32_bf16 v[48:51], v[8:11], v[120:123], v[48:51]
  v_max3_u32 v12, v12, v127, v131
  v_mfma_f32_16x16x32_bf16 v[48:51], v[8:11], v[124:127], v[48:51]
  v_mfma_f32_16x16x32_bf16 v[48:51], v[8:11], v[128:131], v[48:51]
  v_max_u32 v12, v12, v135
  v_mfma_f32_16x16x32_bf16 v[48:51], v[8:11], v[132:135], v[48:51]
  v_cmp_eq_u32 vcc, -1, v12
  s_and_b64 vcc, vcc, s[44:45]
  s_cbranch_vccz OK_54
  s_sub_u32 s40, s40, 1
  s_cbranch_scc1 BAIL
  v_cmp_eq_u32 vcc, -1, v103
  s_cbranch_vccz SK_55
  s_add_u32 s38, s41, 0
  buffer_load_dwordx4 v[100:103], v32, s[4:7], s38 offen sc1
SK_55:
  v_cmp_eq_u32 vcc, -1, v107
  s_cbranch_vccz SK_56
  s_add_u32 s38, s41, 5120
  buffer_load_dwordx4 v[104:107], v32, s[4:7], s38 offen sc1
SK_56:
  v_cmp_eq_u32 vcc, -1, v111
  s_cbranch_vccz SK_57
  s_add_u32 s38, s41, 10240
  buffer_load_dwordx4 v[108:111], v32, s[4:7], s38 offen sc1
SK_57:
  v_cmp_eq_u32 vcc, -1, v115
  s_cbranch_vccz SK_58
  s_add_u32 s38, s41, 15360
  buffer_load_dwordx4 v[112:115], v32, s[4:7], s38 offen sc1
SK_58:
  v_cmp_eq_u32 vcc, -1, v119
  s_cbranch_vccz SK_59
  s_add_u32 s38, s41, 20480
  buffer_load_dwordx4 v[116:119], v32, s[4:7], s38 offen sc1
SK_59:
  v_cmp_eq_u32 vcc, -1, v123
  s_cbranch_vccz SK_60
  s_add_u32 s38, s41, 25600
  buffer_load_dwordx4 v[120:123], v32, s[4:7], s38 offen sc1
SK_60:
  v_cmp_eq_u32 vcc, -1, v127
  s_cbranch_vccz SK_61
  s_add_u32 s38, s41, 30720
  buffer_load_dwordx4 v[124:127], v32, s[4:7], s38 offen sc1
SK_61:
  v_cmp_eq_u32 vcc, -1, v131
  s_cbranch_vccz SK_62
  s_add_u32 s38, s41, 35840
  buffer_load_dwordx4 v[128:131], v32, s[4:7], s38 offen sc1
SK_62:
  v_cmp_eq_u32 vcc, -1, v135
  s_cbranch_vccz SK_63
  s_and_b64 exec, s[62:63], 0xffff
  buffer_load_dwordx4 v[132:135], v32, s[32:35], s47 offen sc1
  s_mov_b64 exec, s[62:63]
SK_63:
  s_branch WT_52
OK_54:
PG_51:
  s_cbranch_execz DRYXM
SEG_64:
  s_bfe_u32 s38, s36, 131076
  s_cmp_eq_u32 s38, 0
  s_cbranch_scc1 X_68
X_65:
  s_nop 0
  v_mov_b32 v48, 1.0
  v_mov_b32 v49, 1.0
  v_mov_b32 v50, 1.0
  v_mov_b32 v51, 1.0
X_68:
  s_nop 0
  v_cvt_pk_bf16_f32 v12, v48, v48
  v_cvt_pk_bf16_f32 v13, v49, v49
  v_cvt_pk_bf16_f32 v14, v50, v50
  v_cvt_pk_bf16_f32 v15, v51, v51
  ds_write_b128 v33, v[12:15] offset:0
  v_cvt_pk_bf16_f32 v16, v48, v49
  v_cvt_pk_bf16_f32 v17, v50, v51
  v_lshrrev_b32 v18, 1, v33
  ds_write_b64 v18, v[16:17] offset:32768
  s_bitcmp1_b32 s36, 3
  s_cbranch_scc0 M_B1
  v_mov_b32 v18, v16
  v_mov_b32 v19, v17
  s_nop 0
  v_permlane16_swap_b32 v16, v18
  v_permlane16_swap_b32 v17, v19
  v_min_u32 v19, -2, v19
  s_and_b64 exec, s[62:63], 0xffff
  buffer_store_dwordx4 v[16:19], v32, s[4:7], s43 offen sc1
  s_mov_b64 exec, s[62:63]
M_B1:
  s_cbranch_execz DRYXM
  s_waitcnt lgkmcnt(0)
  s_barrier
SEG_69:
  ds_read2_b32 v[52:53], v34 offset0:0 offset1:8
  ds_read2_b32 v[54:55], v34 offset0:16 offset1:24
  ds_read2_b32 v[56:57], v34 offset0:32 offset1:40
  ds_read2_b32 v[58:59], v34 offset0:48 offset1:56
  ds_read2_b32 v[60:61], v34 offset0:64 offset1:72
  s_bitcmp1_b32 s36, 11
  s_cbranch_scc0 W_70
  s_waitcnt vmcnt(0)
W_70:
  s_cmp_eq_u32 s51, 7
  s_cbranch_scc1 S7_71
  s_waitcnt lgkmcnt(0)
  v_and_b32 v72, v52, v4
  v_and_b32 v73, v52, v5
  v_and_b32 v74, v52, v6
  v_and_b32 v75, v52, v7
  s_nop 1
  v_mfma_f32_16x16x32_bf16 v[12:15], v[72:75], v[136:139], 0
  v_mfma_f32_16x16x32_bf16 v[16:19], v[72:75], v[176:179], 0
  v_and_b32 v76, v53, v4
  v_and_b32 v77, v53, v5
  v_and_b32 v78, v53, v6
  v_and_b32 v79, v53, v7
  s_nop 1
  v_mfma_f32_16x16x32_bf16 v[12:15], v[76:79], v[140:143], v[12:15]
  v_mfma_f32_16x16x32_bf16 v[16:19], v[76:79], v[180:183], v[16:19]
  v_and_b32 v72, v54, v4
  v_and_b32 v73, v54, v5
  v_and_b32 v74, v54, v6
  v_and_b32 v75, v54, v7
  s_nop 1
  v_mfma_f32_16x16x32_bf16 v[12:15], v[72:75], v[144:147], v[12:15]
  v_mfma_f32_16x16x32_bf16 v[16:19], v[72:75], v[184:187], v[16:19]
  v_and_b32 v76, v55, v4
  v_and_b32 v77, v55, v5
  v_and_b32 v78, v55, v6
  v_and_b32 v79, v55, v7
  s_nop 1
  v_mfma_f32_16x16x32_bf16 v[12:15], v[76:79], v[148:151], v[12:15]
  v_mfma_f32_16x16x32_bf16 v[16:19], v[76:79], v[188:191], v[16:19]
  v_and_b32 v72, v56, v4
  v_and_b32 v73, v56, v5
  v_and_b32 v74, v56, v6
  v_and_b32 v75, v56, v7
  s_nop 1
  v_mfma_f32_16x16x32_bf16 v[12:15], v[72:75], v[152:155], v[12:15]
  v_mfma_f32_16x16x32_bf16 v[16:19], v[72:75], v[192:195], v[16:19]
  s_cbranch_execz DRYXM
SEG_73:
  v_and_b32 v76, v57, v4
  v_and_b32 v77, v57, v5
  v_and_b32 v78, v57, v6
  v_and_b32 v79, v57, v7
  s_nop 1
  v_mfma_f32_16x16x32_bf16 v[12:15], v[76:79], v[156:159], v[12:15]
  v_mfma_f32_16x16x32_bf16 v[16:19], v[76:79], v[196:199], v[16:19]
  v_and_b32 v72, v58, v4
  v_and_b32 v73, v58, v5
  v_and_b32 v74, v58, v6
  v_and_b32 v75, v58, v7
  s_nop 1
  v_mfma_f32_16x16x32_bf16 v[12:15], v[72:75], v[160:163], v[12:15]
  v_mfma_f32_16x16x32_bf16 v[16:19], v[72:75], v[200:203], v[16:19]
  v_and_b32 v76, v59, v4
  v_and_b32 v77, v59, v5
  v_and_b32 v78, v59, v6
  v_and_b32 v79, v59, v7
  s_nop 1
  v_mfma_f32_16x16x32_bf16 v[12:15], v[76:79], v[164:167], v[12:15]
  v_mfma_f32_16x16x32_bf16 v[16:19], v[76:79], v[204:207], v[16:19]
  v_and_b32 v72, v60, v4
  v_and_b32 v73, v60, v5
  v_and_b32 v74, v60, v6
  v_and_b32 v75, v60, v7
  s_nop 1
  v_mfma_f32_16x16x32_bf16 v[12:15], v[72:75], v[168:171], v[12:15]
  v_mfma_f32_16x16x32_bf16 v[16:19], v[72:75], v[208:211], v[16:19]
  v_and_b32 v76, v61, v4
  v_and_b32 v77, v61, v5
  v_and_b32 v78, v61, v6
  v_and_b32 v79, v61, v7
  s_nop 1
  v_mfma_f32_16x16x32_bf16 v[12:15], v[76:79], v[172:175], v[12:15]
  v_mfma_f32_16x16x32_bf16 v[16:19], v[76:79], v[212:215], v[16:19]
  s_branch SE_72
S7_71:
SEG_74:
  s_setprio 3
  ds_read2_b32 v[62:63], v35 offset0:0 offset1:1
  ds_read2_b32 v[64:65], v35 offset0:2 offset1:3
  ds_read_b32 v66, v35 offset:16
  s_waitcnt lgkmcnt(0)
  v_mov_b32 v20, 0
  v_mov_b32 v21, 0
  v_dot2c_f32_bf16 v20, s46, v62
  v_dot2c_f32_bf16 v21, v62, v62
  v_dot2c_f32_bf16 v20, s46, v63
  v_dot2c_f32_bf16 v21, v63, v63
  v_dot2c_f32_bf16 v20, s46, v64
  v_dot2c_f32_bf16 v21, v64, v64
  v_dot2c_f32_bf16 v20, s46, v65
  v_dot2c_f32_bf16 v21, v65, v65
  v_dot2c_f32_bf16 v20, s46, v66
  v_dot2c_f32_bf16 v21, v66, v66
  v_and_b32 v72, v52, v4
  v_and_b32 v73, v52, v5
  v_add_f32_dpp v20, v20, v20 quad_perm:[1,0,3,2] row_mask:0xf bank_mask:0xf
  v_and_b32 v74, v52, v6
  v_and_b32 v75, v52, v7
  v_add_f32_dpp v21, v21, v21 quad_perm:[1,0,3,2] row_mask:0xf bank_mask:0xf
  s_nop 0
  v_mfma_f32_16x16x32_bf16 v[12:15], v[72:75], v[136:139], 0
  v_mfma_f32_16x16x32_bf16 v[16:19], v[72:75], v[176:179], 0
  v_add_f32_dpp v20, v20, v20 quad_perm:[2,3,0,1] row_mask:0xf bank_mask:0xf
  v_and_b32 v76, v53, v4
  v_add_f32_dpp v21, v21, v21 quad_perm:[2,3,0,1] row_mask:0xf bank_mask:0xf
  v_and_b32 v77, v53, v5
  v_and_b32 v78, v53, v6
  v_add_f32_dpp v20, v20, v20 row_half_mirror row_mask:0xf bank_mask:0xf
  v_and_b32 v79, v53, v7
  s_nop 1
  v_mfma_f32_16x16x32_bf16 v[12:15], v[76:79], v[140:143], v[12:15]
  v_add_f32_dpp v21, v21, v21 row_half_mirror row_mask:0xf bank_mask:0xf
  v_mfma_f32_16x16x32_bf16 v[16:19], v[76:79], v[180:183], v[16:19]
  v_add_f32_dpp v20, v20, v20 row_mirror row_mask:0xf bank_mask:0xf
  v_and_b32 v72, v54, v4
  v_and_b32 v73, v54, v5
  v_add_f32_dpp v21, v21, v21 row_mirror row_mask:0xf bank_mask:0xf
  v_and_b32 v74, v54, v6
  v_and_b32 v75, v54, v7
  v_mov_b32 v22, v20
  s_nop 0
  v_mfma_f32_16x16x32_bf16 v[12:15], v[72:75], v[144:147], v[12:15]
  v_mfma_f32_16x16x32_bf16 v[16:19], v[72:75], v[184:187], v[16:19]
  v_mov_b32 v23, v21
  v_and_b32 v76, v55, v4
  v_permlane16_swap_b32 v20, v22
  v_and_b32 v77, v55, v5
  v_and_b32 v78, v55, v6
  v_permlane16_swap_b32 v21, v23
  v_and_b32 v79, v55, v7
  s_nop 1
  v_mfma_f32_16x16x32_bf16 v[12:15], v[76:79], v[148:151], v[12:15]
  v_add_f32 v20, v20, v22
  v_mfma_f32_16x16x32_bf16 v[16:19], v[76:79], v[188:191], v[16:19]
  v_add_f32 v21, v21, v23
  v_and_b32 v72, v56, v4
  v_and_b32 v73, v56, v5
  v_mov_b32 v22, v20
  s_cbranch_execz DRYXM
SEG_75:
  v_and_b32 v74, v56, v6
  v_and_b32 v75, v56, v7
  v_mov_b32 v23, v21
  s_nop 0
  v_mfma_f32_16x16x32_bf16 v[12:15], v[72:75], v[152:155], v[12:15]
  v_mfma_f32_16x16x32_bf16 v[16:19], v[72:75], v[192:195], v[16:19]
  v_permlane32_swap_b32 v20, v22
  v_and_b32 v76, v57, v4
  v_permlane32_swap_b32 v21, v23
  v_and_b32 v77, v57, v5
  v_and_b32 v78, v57, v6
  v_add_f32 v20, v20, v22
  v_and_b32 v79, v57, v7
  s_nop 1
  v_mfma_f32_16x16x32_bf16 v[12:15], v[76:79], v[156:159], v[12:15]
  v_add_f32 v21, v21, v23
  v_mfma_f32_16x16x32_bf16 v[16:19], v[76:79], v[196:199], v[16:19]
  v_mul_f32 v20, 986500301, v20
  v_and_b32 v72, v58, v4
  v_and_b32 v73, v58, v5
  v_mul_f32 v21, 986500301, v21
  v_and_b32 v74, v58, v6
  v_and_b32 v75, v58, v7
  v_fma_f32 v21, -v20, v20, v21
  s_nop 0
  v_mfma_f32_16x16x32_bf16 v[12:15], v[72:75], v[160:163], v[12:15]
  v_mfma_f32_16x16x32_bf16 v[16:19], v[72:75], v[200:203], v[16:19]
  v_max_f32 v21, 0, v21
  v_and_b32 v76, v59, v4
  v_cvt_pk_bf16_f32 v44, v20, v20
  v_and_b32 v77, v59, v5
  v_and_b32 v78, v59, v6
  v_and_b32 v44, 0xffff0000, v44
  v_and_b32 v79, v59, v7
  s_nop 1
  v_mfma_f32_16x16x32_bf16 v[12:15], v[76:79], v[164:167], v[12:15]
  v_cvt_pk_bf16_f32 v21, v21, v21
  v_mfma_f32_16x16x32_bf16 v[16:19], v[76:79], v[204:207], v[16:19]
  v_and_b32 v21, 0xffff0000, v21
  v_and_b32 v72, v60, v4
  v_and_b32 v73, v60, v5
  v_add_f32 v21, 925353388, v21
  v_and_b32 v74, v60, v6
  v_and_b32 v75, v60, v7
  v_cvt_pk_bf16_f32 v21, v21, v21
  s_nop 0
  v_mfma_f32_16x16x32_bf16 v[12:15], v[72:75], v[168:171], v[12:15]
  v_mfma_f32_16x16x32_bf16 v[16:19], v[72:75], v[208:211], v[16:19]
  v_and_b32 v21, 0xffff0000, v21
  v_and_b32 v76, v61, v4
  v_sqrt_f32 v21, v21
  v_and_b32 v77, v61, v5
  v_and_b32 v78, v61, v6
  v_cvt_pk_bf16_f32 v21, v21, v21
  v_and_b32 v79, v61, v7
  s_nop 1
  v_mfma_f32_16x16x32_bf16 v[12:15], v[76:79], v[172:175], v[12:15]
  v_and_b32 v21, 0xffff0000, v21
  v_mfma_f32_16x16x32_bf16 v[16:19], v[76:79], v[212:215], v[16:19]
  v_rcp_f32 v45, v21
  s_setprio 0
  s_bitcmp1_b32 s36, 6
  s_cbranch_scc0 W_76
  v_mov_b32 v44, 0
  v_mov_b32 v45, 1.0
W_76:
  v_mov_b32 v20, 11136
  ds_write_b64 v20, v[44:45]
  s_cbranch_execz DRYXM
SE_72:
  s_and_b32 exec_lo, s62, 0x00ff00ff
  s_and_b32 exec_hi, s62, 0xff00ff00
  s_nop 3
  ds_write_b128 v36, v[12:15] offset:2560
  ds_write_b128 v36, v[16:19] offset:2816
  s_mov_b64 exec, s[62:63]
  v_mov_b32 v20, 11136
  s_cbranch_execz DRYXM
  s_waitcnt lgkmcnt(0)
  s_barrier
SEG_77:
  ds_read_b64 v[44:45], v20
  ds_read_b32 v12, v39 offset:2560
  ds_read_b32 v13, v39 offset:3088
  ds_read_b32 v14, v39 offset:3616
  ds_read_b32 v15, v39 offset:4144
  s_waitcnt lgkmcnt(0)
  v_add_f32 v12, v12, v13
  v_add_f32 v14, v14, v15
  v_add_f32 v12, v12, v14
  s_nop 1
  v_add_f32_dpp v12, v12, v12 quad_perm:[1,0,3,2] row_mask:0xf bank_mask:0xf
  s_nop 1
  v_add_f32_dpp v12, v12, v12 quad_perm:[2,3,0,1] row_mask:0xf bank_mask:0xf
  s_bitcmp1_b32 s36, 7
  s_cbranch_scc0 C_78
  v_mov_b32 v43, v12
C_78:
  v_fma_f32 v12, -v44, v43, v12
  v_mul_f32 v12, v12, v45
  v_cvt_pk_bf16_f32 v12, v12, v12
  v_and_b32 v12, 0xffff0000, v12
  s_nop 1
  v_mov_b32_dpp v13, v12 row_half_mirror row_mask:0xf bank_mask:0xf
  v_cndmask_b32 v14, v12, v13, s[60:61]
  v_cndmask_b32 v15, v13, v12, s[60:61]
  v_mul_f32 v16, v14, v14
  v_mov_b32 v17, 3222493025
  v_fmac_f32 v17, 3184710632, v16
  v_mul_f32 v17, v17, v14
  v_exp_f32 v17, v17
  s_nop 0
  v_add_f32 v17, 1.0, v17
  v_rcp_f32 v17, v17
  s_nop 0
  v_mul_f32 v14, v14, v17
  v_cvt_pk_bf16_f32 v14, v14, v14
  v_and_b32 v14, 0xffff0000, v14
  v_mul_f32 v14, v14, v15
  v_cvt_pk_bf16_f32 v14, v14, v14
  s_cbranch_execz DRYXM
SEG_79:
  s_nop 0
  v_and_b32_dpp v72, v14, v4 row_newbcast:0 row_mask:0xf bank_mask:0xf
  v_and_b32_dpp v73, v14, v5 row_newbcast:0 row_mask:0xf bank_mask:0xf
  v_and_b32_dpp v74, v14, v6 row_newbcast:0 row_mask:0xf bank_mask:0xf
  v_and_b32_dpp v75, v14, v7 row_newbcast:0 row_mask:0xf bank_mask:0xf
  s_nop 1
  v_mfma_f32_16x16x32_bf16 v[80:83], v[72:75], v[216:219], 0
  v_mfma_f32_16x16x32_bf16 v[84:87], v[72:75], v[220:223], 0
  v_mfma_f32_16x16x32_bf16 v[88:91], v[72:75], v[224:227], 0
  v_mfma_f32_16x16x32_bf16 v[92:95], v[72:75], v[228:231], 0
  v_mfma_f32_16x16x32_bf16 v[96:99], v[72:75], v[232:235], 0
  v_and_b32_dpp v76, v14, v4 row_newbcast:8 row_mask:0xf bank_mask:0xf
  v_and_b32_dpp v77, v14, v5 row_newbcast:8 row_mask:0xf bank_mask:0xf
  v_and_b32_dpp v78, v14, v6 row_newbcast:8 row_mask:0xf bank_mask:0xf
  v_and_b32_dpp v79, v14, v7 row_newbcast:8 row_mask:0xf bank_mask:0xf
  s_nop 1
  v_mfma_f32_16x16x32_bf16 v[80:83], v[76:79], v[236:239], v[80:83]
  v_mfma_f32_16x16x32_bf16 v[84:87], v[76:79], v[240:243], v[84:87]
  v_mfma_f32_16x16x32_bf16 v[88:91], v[76:79], v[244:247], v[88:91]
  v_mfma_f32_16x16x32_bf16 v[92:95], v[76:79], v[248:251], v[92:95]
  v_mfma_f32_16x16x32_bf16 v[96:99], v[76:79], v[252:255], v[96:99]
  s_cbranch_execz DRYXM
SEG_80:
  s_mov_b32 exec_hi, 0
  s_nop 1
  ds_write_b128 v40, v[80:83] offset:11264
  ds_write_b128 v40, v[84:87] offset:11776
  ds_write_b128 v40, v[88:91] offset:12288
  ds_write_b128 v40, v[92:95] offset:12800
  ds_write_b128 v40, v[96:99] offset:13312
  s_mov_b64 exec, s[62:63]
  s_cbranch_execz DRYXM
  s_waitcnt lgkmcnt(0)
  s_barrier
SEG_81:
  s_cmp_ge_u32 s51, 5
  s_cbranch_scc1 M_NXT
  ds_read_b128 v[52:55], v41 offset:11264
  ds_read_b128 v[56:59], v41 offset:13840
  ds_read_b128 v[60:63], v41 offset:16416
  ds_read_b128 v[64:67], v41 offset:18992
  s_waitcnt lgkmcnt(2)
  v_add_f32 v52, v52, v56
  v_add_f32 v53, v53, v57
  v_add_f32 v54, v54, v58
  v_add_f32 v55, v55, v59
  s_waitcnt lgkmcnt(0)
  v_add_f32 v60, v60, v64
  v_add_f32 v61, v61, v65
  v_add_f32 v62, v62, v66
  v_add_f32 v63, v63, v67
  v_add_f32 v52, v52, v60
  v_add_f32 v53, v53, v61
  v_add_f32 v54, v54, v62
  v_add_f32 v55, v55, v63
  v_add_f32_dpp v52, v52, v52 quad_perm:[1,0,3,2] row_mask:0xf bank_mask:0xf
  v_add_f32_dpp v53, v53, v53 quad_perm:[1,0,3,2] row_mask:0xf bank_mask:0xf
  v_add_f32_dpp v54, v54, v54 quad_perm:[1,0,3,2] row_mask:0xf bank_mask:0xf
  v_add_f32_dpp v55, v55, v55 quad_perm:[1,0,3,2] row_mask:0xf bank_mask:0xf
  v_cvt_pk_bf16_f32 v56, v52, v53
  v_cvt_pk_bf16_f32 v57, v54, v55
  s_nop 0
  v_mov_b32_dpp v58, v56 quad_perm:[2,3,0,1] row_mask:0xf bank_mask:0xf
  v_mov_b32_dpp v59, v57 quad_perm:[2,3,0,1] row_mask:0xf bank_mask:0xf
  v_min_u32 v59, -2, v59
  s_bitcmp1_b32 s36, 2
  s_cbranch_scc0 M_NXT
  s_and_b32 exec_lo, s62, 0x11111111
  s_and_b32 exec_hi, s62, 0x11111111
  buffer_store_dwordx4 v[56:59], v42, s[4:7], s42 offen sc1
  s_mov_b64 exec, s[62:63]
M_NXT:
  s_cbranch_execz DRYXM
  s_bitcmp1_b32 s36, 8
  s_cbranch_scc1 BAIL
  s_branch M_LOOP
DRYXM:
  s_add_u32 s59, s59, 8
DRYNM:
  s_mov_b64 exec, 0
  s_mov_b64 s[62:63], 0
  s_cmp_eq_u32 s59, 0
  s_cbranch_scc1 SEG_50
  s_cmp_eq_u32 s59, 1
  s_cbranch_scc1 SEG_64
  s_cmp_eq_u32 s59, 2
  s_cbranch_scc1 SEG_69
  s_cmp_eq_u32 s59, 3
  s_cbranch_scc1 SEG_73
  s_cmp_eq_u32 s59, 4
  s_cbranch_scc1 SEG_74
  s_cmp_eq_u32 s59, 5
  s_cbranch_scc1 SEG_75
  s_cmp_eq_u32 s59, 6
  s_cbranch_scc1 SEG_77
  s_cmp_eq_u32 s59, 7
  s_cbranch_scc1 SEG_79
  s_cmp_eq_u32 s59, 8
  s_cbranch_scc1 SEG_80
  s_cmp_eq_u32 s59, 9
  s_cbranch_scc1 SEG_81
  s_mov_b64 exec, -1
  s_mov_b64 s[62:63], -1
  s_mov_b32 s51, s3
  s_branch DRYDM
ROLE_O:
  s_load_dwordx2 s[12:13], s[0:1], 32
  s_mov_b32 s14, 4194304
  s_mov_b32 s15, 0x20000
  s_load_dwordx2 s[16:17], s[0:1], 40
  s_mov_b32 s18, 5242880
  s_mov_b32 s19, 0x20000
  s_sub_u32 s48, s2, 192
  s_and_b32 s38, s48, 7
  s_lshl_b32 s38, s38, 2
  s_lshr_b32 s48, s48, 3
  s_add_u32 s48, s48, s38
  s_mov_b32 s37, 1
  v_lshlrev_b32 v12, 4, v3
  v_lshl_add_u32 v12, v2, 5, v12
  s_mul_i32 s38, s3, 2576
  v_add_u32 v36, s38, v12
  v_and_b32 v12, 1, v0
  v_mul_u32_u24 v12, 10304, v12
  v_lshrrev_b32 v13, 1, v0
  v_lshl_add_u32 v37, v13, 4, v12
  v_lshrrev_b32 v13, 2, v0
  v_lshlrev_b32 v38, 4, v13
  s_mul_i32 s50, s48, 1280
  s_add_u32 s50, s50, 2195456
  s_waitcnt lgkmcnt(0)
  s_lshl_b32 s38, s3, 19
  s_lshl_b32 s39, s48, 8
  s_add_u32 s38, s38, s39
  v_lshrrev_b32 v12, 1, v3
  v_lshlrev_b32 v12, 18, v12
  v_and_b32 v13, 1, v3
  v_lshl_add_u32 v12, v13, 15, v12
  v_lshl_add_u32 v12, v2, 4, v12
  v_add_u32 v41, s38, v12
  s_lshl_b32 s38, s48, 7
  s_lshl_b32 s39, s3, 4
  s_add_u32 s38, s38, s39
  s_mul_i32 s38, s38, 1280
  v_mul_u32_u24 v12, 1280, v3
  v_lshl_add_u32 v12, v2, 4, v12
  v_add_u32 v108, s38, v12
  v_lshrrev_b32 v12, 3, v2
  v_lshl_add_u32 v12, v12, 2, v3
  v_and_b32 v13, 7, v2
  s_lshl_b32 s38, s48, 16
  s_lshl_b32 s39, s3, 7
  s_add_u32 s38, s38, s39
  v_lshlrev_b32 v32, 13, v12
  v_lshl_add_u32 v32, v13, 4, v32
  v_add_u32 v32, s38, v32
  v_lshl_add_u32 v33, v12, 3, v13
  s_lshl_b32 s38, s48, 9
  s_add_u32 s38, s38, 2097152
  v_lshl_add_u32 v33, v33, 3, s38
  v_and_b32 v12, 1, v3
  v_lshlrev_b32 v12, 4, v12
  v_lshl_add_u32 v12, v2, 5, v12
  s_mul_i32 s38, s3, 528
  v_add_u32 v34, s38, v12
  v_and_b32 v12, 3, v1
  v_mul_u32_u24 v12, 1056, v12
  v_and_b32 v13, 12, v1
  v_add_u32 v13, v13, v3
  v_lshl_add_u32 v12, v13, 2, v12
  s_lshl_b32 s38, s3, 6
  v_add_u32 v35, s38, v12
  s_mov_b32 s36, 0
  s_mov_b64 s[44:45], 0
  s_mov_b32 s59, s3
  s_mov_b32 s51, 0
  s_branch DRYNO
DRYDO:
  s_mov_b32 s38, 0
  buffer_load_dwordx4 v[112:115], v41, s[12:15], s38 offen nt
  s_mov_b32 s38, 65536
  buffer_load_dwordx4 v[116:119], v41, s[12:15], s38 offen nt
  s_mov_b32 s38, 131072
  buffer_load_dwordx4 v[120:123], v41, s[12:15], s38 offen nt
  s_mov_b32 s38, 196608
  buffer_load_dwordx4 v[124:127], v41, s[12:15], s38 offen nt
  s_mov_b32 s38, 8192
  buffer_load_dwordx4 v[128:131], v41, s[12:15], s38 offen nt
  s_mov_b32 s38, 73728
  buffer_load_dwordx4 v[132:135], v41, s[12:15], s38 offen nt
  s_mov_b32 s38, 139264
  buffer_load_dwordx4 v[136:139], v41, s[12:15], s38 offen nt
  s_mov_b32 s38, 204800
  buffer_load_dwordx4 v[140:143], v41, s[12:15], s38 offen nt
  s_mov_b32 s38, 16384
  buffer_load_dwordx4 v[144:147], v41, s[12:15], s38 offen nt
  s_mov_b32 s38, 81920
  buffer_load_dwordx4 v[148:151], v41, s[12:15], s38 offen nt
  s_mov_b32 s38, 147456
  buffer_load_dwordx4 v[152:155], v41, s[12:15], s38 offen nt
  s_mov_b32 s38, 212992
  buffer_load_dwordx4 v[156:159], v41, s[12:15], s38 offen nt
  s_mov_b32 s38, 24576
  buffer_load_dwordx4 v[160:163], v41, s[12:15], s38 offen nt
  s_mov_b32 s38, 90112
  buffer_load_dwordx4 v[164:167], v41, s[12:15], s38 offen nt
  s_mov_b32 s38, 155648
  buffer_load_dwordx4 v[168:171], v41, s[12:15], s38 offen nt
  s_mov_b32 s38, 221184
  buffer_load_dwordx4 v[172:175], v41, s[12:15], s38 offen nt
  s_cmp_lg_u32 s3, 0
  s_cbranch_scc1 F_82
  buffer_load_dword v29, v28, s[8:11], 0 offen
F_82:
  s_waitcnt vmcnt(0)
  s_cmp_lg_u32 s3, 0
  s_cbranch_scc1 F_83
F_84:
  v_cmp_ne_u32 vcc, 1, v29
  s_and_b64 vcc, vcc, 255
  s_cbranch_vccz F_83
  s_sub_u32 s40, s40, 1
  s_cbranch_scc1 BAIL
  s_sleep 8
  buffer_load_dword v29, v28, s[8:11], 0 offen sc1
  s_waitcnt vmcnt(0)
  s_branch F_84
F_83:
  s_barrier
  s_mov_b32 s38, 0
  buffer_load_dwordx4 v[176:179], v108, s[16:19], s38 offen offset:0 nt
  s_mov_b32 s38, 0
  buffer_load_dwordx4 v[180:183], v108, s[16:19], s38 offen offset:256 nt
  s_mov_b32 s38, 0
  buffer_load_dwordx4 v[184:187], v108, s[16:19], s38 offen offset:512 nt
  s_mov_b32 s38, 0
  buffer_load_dwordx4 v[188:191], v108, s[16:19], s38 offen offset:768 nt
  s_mov_b32 s38, 0
  buffer_load_dwordx4 v[192:195], v108, s[16:19], s38 offen offset:1024 nt
  s_mov_b32 s38, 5120
  buffer_load_dwordx4 v[196:199], v108, s[16:19], s38 offen offset:0 nt
  s_mov_b32 s38, 5120
  buffer_load_dwordx4 v[200:203], v108, s[16:19], s38 offen offset:256 nt
  s_mov_b32 s38, 5120
  buffer_load_dwordx4 v[204:207], v108, s[16:19], s38 offen offset:512 nt
  s_mov_b32 s38, 5120
  buffer_load_dwordx4 v[208:211], v108, s[16:19], s38 offen offset:768 nt
  s_mov_b32 s38, 5120
  buffer_load_dwordx4 v[212:215], v108, s[16:19], s38 offen offset:1024 nt
  s_mov_b32 s38, 10240
  buffer_load_dwordx4 v[216:219], v108, s[16:19], s38 offen offset:0 nt
  s_mov_b32 s38, 10240
  buffer_load_dwordx4 v[220:223], v108, s[16:19], s38 offen offset:256 nt
  s_mov_b32 s38, 10240
  buffer_load_dwordx4 v[224:227], v108, s[16:19], s38 offen offset:512 nt
  s_mov_b32 s38, 10240
  buffer_load_dwordx4 v[228:231], v108, s[16:19], s38 offen offset:768 nt
  s_mov_b32 s38, 10240
  buffer_load_dwordx4 v[232:235], v108, s[16:19], s38 offen offset:1024 nt
  s_mov_b32 s38, 15360
  buffer_load_dwordx4 v[236:239], v108, s[16:19], s38 offen offset:0 nt
  s_mov_b32 s38, 15360
  buffer_load_dwordx4 v[240:243], v108, s[16:19], s38 offen offset:256 nt
  s_mov_b32 s38, 15360
  buffer_load_dwordx4 v[244:247], v108, s[16:19], s38 offen offset:512 nt
  s_mov_b32 s38, 15360
  buffer_load_dwordx4 v[248:251], v108, s[16:19], s38 offen offset:768 nt
  s_mov_b32 s38, 15360
  buffer_load_dwordx4 v[252:255], v108, s[16:19], s38 offen offset:1024 nt
  s_cmp_lg_u32 s3, 0
  s_cbranch_scc1 R_85
  s_lshr_b32 s38, s48, 4
  s_lshl_b32 s38, s38, 13
  s_add_u32 s38, s38, 2113536
  v_lshlrev_b32 v12, 7, v1
R_86:
  buffer_load_dword v13, v12, s[4:7], s38 offen sc1
  s_waitcnt vmcnt(0)
  v_cmp_eq_u32 vcc, -1, v13
  s_cbranch_vccz R_85
  s_sub_u32 s40, s40, 1
  s_cbranch_scc1 BAIL
  s_sleep 8
  s_branch R_86
R_85:
  s_barrier
  s_mov_b32 s52, 3170310
  s_mov_b32 s53, 0
O_LOOP:
  s_and_b32 s36, s52, 0xfff
  s_lshr_b64 s[52:53], s[52:53], 12
  s_bitcmp1_b32 s36, 1
  s_cselect_b64 s[44:45], -1, 0
  s_bitcmp1_b32 s36, 9
  s_cselect_b32 s41, 4194304, 0
  s_add_u32 s41, s41, 0
  s_add_u32 s43, s41, 4096
  s_add_u32 s42, s41, s50
SEG_87:
  buffer_load_dwordx2 v[42:43], v33, s[4:7], s41 offen sc1
  buffer_load_dwordx4 v[76:79], v32, s[4:7], s41 offen offset:0 sc1
  buffer_load_dwordx4 v[80:83], v32, s[4:7], s41 offen offset:1024 sc1
  buffer_load_dwordx4 v[84:87], v32, s[4:7], s41 offen offset:2048 sc1
  buffer_load_dwordx4 v[88:91], v32, s[4:7], s41 offen offset:3072 sc1
  buffer_load_dwordx4 v[92:95], v32, s[4:7], s43 offen offset:0 sc1
  buffer_load_dwordx4 v[96:99], v32, s[4:7], s43 offen offset:1024 sc1
  buffer_load_dwordx4 v[100:103], v32, s[4:7], s43 offen offset:2048 sc1
  buffer_load_dwordx4 v[104:107], v32, s[4:7], s43 offen offset:3072 sc1
  s_bitcmp1_b32 s36, 1
  s_cbranch_scc0 NW_89
WT_88:
  s_waitcnt vmcnt(0)
NW_89:
  v_mov_b32 v13, v42
  s_nop 1
  v_max_f32_dpp v13, v13, v13 quad_perm:[1,0,3,2] row_mask:0xf bank_mask:0xf
  s_nop 1
  v_max_f32_dpp v13, v13, v13 quad_perm:[2,3,0,1] row_mask:0xf bank_mask:0xf
  v_max_u32 v12, v42, v79
  s_nop 0
  v_max_f32_dpp v13, v13, v13 row_half_mirror row_mask:0xf bank_mask:0xf
  s_nop 1
  v_max_f32_dpp v13, v13, v13 row_mirror row_mask:0xf bank_mask:0xf
  v_max3_u32 v12, v12, v83, v87
  v_mov_b32 v14, v13
  s_nop 1
  v_permlane16_swap_b32 v13, v14
  v_max3_u32 v12, v12, v91, v95
  v_max_f32 v13, v13, v14
  v_mov_b32 v14, v13
  s_nop 1
  v_permlane32_swap_b32 v13, v14
  v_max3_u32 v12, v12, v99, v103
  v_max_f32 v13, v13, v14
  v_sub_f32 v13, v42, v13
  v_max_u32 v12, v12, v107
  v_exp_f32 v13, v13
  s_nop 0
  v_cvt_pk_bf16_f32 v39, v13, v13
  v_cmp_eq_u32 vcc, -1, v12
  s_and_b64 vcc, vcc, s[44:45]
  s_cbranch_vccz OK_90
  s_sub_u32 s40, s40, 1
  s_cbranch_scc1 BAIL
  v_cmp_eq_u32 vcc, -1, v42
  s_cbranch_vccz SK_91
  buffer_load_dwordx2 v[42:43], v33, s[4:7], s41 offen sc1
SK_91:
  v_cmp_eq_u32 vcc, -1, v79
  s_cbranch_vccz SK_92
  buffer_load_dwordx4 v[76:79], v32, s[4:7], s41 offen offset:0 sc1
SK_92:
  v_cmp_eq_u32 vcc, -1, v83
  s_cbranch_vccz SK_93
  buffer_load_dwordx4 v[80:83], v32, s[4:7], s41 offen offset:1024 sc1
SK_93:
  v_cmp_eq_u32 vcc, -1, v87
  s_cbranch_vccz SK_94
  buffer_load_dwordx4 v[84:87], v32, s[4:7], s41 offen offset:2048 sc1
SK_94:
  v_cmp_eq_u32 vcc, -1, v91
  s_cbranch_vccz SK_95
  buffer_load_dwordx4 v[88:91], v32, s[4:7], s41 offen offset:3072 sc1
SK_95:
  v_cmp_eq_u32 vcc, -1, v95
  s_cbranch_vccz SK_96
  buffer_load_dwordx4 v[92:95], v32, s[4:7], s43 offen offset:0 sc1
SK_96:
  v_cmp_eq_u32 vcc, -1, v99
  s_cbranch_vccz SK_97
  buffer_load_dwordx4 v[96:99], v32, s[4:7], s43 offen offset:1024 sc1
SK_97:
  v_cmp_eq_u32 vcc, -1, v103
  s_cbranch_vccz SK_98
  buffer_load_dwordx4 v[100:103], v32, s[4:7], s43 offen offset:2048 sc1
SK_98:
  v_cmp_eq_u32 vcc, -1, v107
  s_cbranch_vccz SK_99
  buffer_load_dwordx4 v[104:107], v32, s[4:7], s43 offen offset:3072 sc1
SK_99:
  s_branch WT_88
OK_90:
  s_cbranch_execz DRYXO
SEG_100:
  v_mov_b32_dpp v14, v39 row_newbcast:0 row_mask:0xf bank_mask:0x3
  v_mov_b32_dpp v14, v39 row_newbcast:8 row_mask:0xf bank_mask:0xc
  v_and_b32 v44, v14, v4
  v_and_b32 v45, v14, v5
  v_and_b32 v46, v14, v6
  v_and_b32 v40, 0xffff0000, v39
  v_and_b32 v47, v14, v7
  s_nop 1
  v_mfma_f32_16x16x32_bf16 v[52:55], v[44:47], v[76:79], 0
  v_mov_b32_dpp v15, v39 row_newbcast:1 row_mask:0xf bank_mask:0x3
  v_mov_b32_dpp v15, v39 row_newbcast:9 row_mask:0xf bank_mask:0xc
  v_mul_f32 v40, v40, v43
  v_and_b32 v48, v15, v4
  v_and_b32 v49, v15, v5
  v_and_b32 v50, v15, v6
  v_and_b32 v51, v15, v7
  v_add_f32_dpp v40, v40, v40 quad_perm:[1,0,3,2] row_mask:0xf bank_mask:0xf
  s_nop 0
  v_mfma_f32_16x16x32_bf16 v[52:55], v[48:51], v[80:83], v[52:55]
  v_mov_b32_dpp v14, v39 row_newbcast:2 row_mask:0xf bank_mask:0x3
  v_mov_b32_dpp v14, v39 row_newbcast:10 row_mask:0xf bank_mask:0xc
  v_and_b32 v44, v14, v4
  v_and_b32 v45, v14, v5
  v_add_f32_dpp v40, v40, v40 quad_perm:[2,3,0,1] row_mask:0xf bank_mask:0xf
  v_and_b32 v46, v14, v6
  v_and_b32 v47, v14, v7
  s_nop 1
  v_mfma_f32_16x16x32_bf16 v[52:55], v[44:47], v[84:87], v[52:55]
  v_mov_b32_dpp v15, v39 row_newbcast:3 row_mask:0xf bank_mask:0x3
  v_add_f32_dpp v40, v40, v40 row_half_mirror row_mask:0xf bank_mask:0xf
  v_mov_b32_dpp v15, v39 row_newbcast:11 row_mask:0xf bank_mask:0xc
  v_and_b32 v48, v15, v4
  v_and_b32 v49, v15, v5
  v_and_b32 v50, v15, v6
  v_add_f32_dpp v40, v40, v40 row_mirror row_mask:0xf bank_mask:0xf
  v_and_b32 v51, v15, v7
  s_nop 1
  v_mfma_f32_16x16x32_bf16 v[52:55], v[48:51], v[88:91], v[52:55]
  s_cbranch_execz DRYXO
SEG_101:
  v_mov_b32_dpp v14, v39 row_newbcast:4 row_mask:0xf bank_mask:0x3
  v_mov_b32_dpp v14, v39 row_newbcast:12 row_mask:0xf bank_mask:0xc
  v_and_b32 v44, v14, v4
  v_mov_b32 v16, v40
  v_and_b32 v45, v14, v5
  v_and_b32 v46, v14, v6
  v_and_b32 v47, v14, v7
  s_nop 1
  v_mfma_f32_16x16x32_bf16 v[52:55], v[44:47], v[92:95], v[52:55]
  v_permlane16_swap_b32 v40, v16
  v_mov_b32_dpp v15, v39 row_newbcast:5 row_mask:0xf bank_mask:0x3
  v_mov_b32_dpp v15, v39 row_newbcast:13 row_mask:0xf bank_mask:0xc
  v_and_b32 v48, v15, v4
  v_and_b32 v49, v15, v5
  v_add_f32 v40, v40, v16
  v_and_b32 v50, v15, v6
  v_and_b32 v51, v15, v7
  s_nop 1
  v_mfma_f32_16x16x32_bf16 v[52:55], v[48:51], v[96:99], v[52:55]
  v_mov_b32_dpp v14, v39 row_newbcast:6 row_mask:0xf bank_mask:0x3
  v_mov_b32_dpp v14, v39 row_newbcast:14 row_mask:0xf bank_mask:0xc
  v_mov_b32 v16, v40
  v_and_b32 v44, v14, v4
  v_and_b32 v45, v14, v5
  v_and_b32 v46, v14, v6
  v_and_b32 v47, v14, v7
  v_permlane32_swap_b32 v40, v16
  s_nop 0
  v_mfma_f32_16x16x32_bf16 v[52:55], v[44:47], v[100:103], v[52:55]
  v_mov_b32_dpp v15, v39 row_newbcast:7 row_mask:0xf bank_mask:0x3
  v_mov_b32_dpp v15, v39 row_newbcast:15 row_mask:0xf bank_mask:0xc
  v_and_b32 v48, v15, v4
  v_add_f32 v40, v40, v16
  v_and_b32 v49, v15, v5
  v_and_b32 v50, v15, v6
  v_and_b32 v51, v15, v7
  s_nop 1
  v_mfma_f32_16x16x32_bf16 v[52:55], v[48:51], v[104:107], v[52:55]
  v_rcp_f32 v40, v40
  s_cbranch_execz DRYXO
SEG_102:
  s_nop 5
  v_mov_b32 v12, v52
  v_mov_b32 v13, v53
  v_mov_b32 v14, v54
  v_mov_b32 v15, v55
  v_permlane32_swap_b32 v52, v12
  v_permlane32_swap_b32 v53, v13
  v_permlane32_swap_b32 v54, v14
  v_permlane32_swap_b32 v55, v15
  v_add_f32_dpp v12, v12, v52 row_ror:8 row_mask:0xf bank_mask:0xf
  v_add_f32_dpp v13, v13, v53 row_ror:8 row_mask:0xf bank_mask:0xf
  v_add_f32_dpp v14, v14, v54 row_ror:8 row_mask:0xf bank_mask:0xf
  v_add_f32_dpp v15, v15, v55 row_ror:8 row_mask:0xf bank_mask:0xf
  v_mul_f32 v12, v12, v40
  v_mul_f32 v13, v13, v40
  v_mul_f32 v14, v14, v40
  v_mul_f32 v15, v15, v40
  v_cvt_pk_bf16_f32 v12, v12, v12
  v_cvt_pk_bf16_f32 v13, v13, v13
  v_cvt_pk_bf16_f32 v14, v14, v14
  v_cvt_pk_bf16_f32 v15, v15, v15
  v_mov_b32_dpp v12, v12 row_shl:4 row_mask:0xc bank_mask:0xf
  v_mov_b32_dpp v13, v13 row_shl:4 row_mask:0xc bank_mask:0xf
  v_mov_b32_dpp v14, v14 row_shl:4 row_mask:0xc bank_mask:0xf
  v_mov_b32_dpp v15, v15 row_shl:4 row_mask:0xc bank_mask:0xf
  v_and_b32_dpp v44, v12, v4 row_newbcast:0 row_mask:0xf bank_mask:0xf
  v_and_b32_dpp v45, v12, v5 row_newbcast:0 row_mask:0xf bank_mask:0xf
  v_and_b32_dpp v46, v12, v6 row_newbcast:0 row_mask:0xf bank_mask:0xf
  v_and_b32_dpp v47, v12, v7 row_newbcast:0 row_mask:0xf bank_mask:0xf
  s_nop 1
  v_mfma_f32_16x16x32_bf16 v[52:55], v[44:47], v[112:115], 0
  v_and_b32_dpp v48, v12, v4 row_newbcast:1 row_mask:0xf bank_mask:0xf
  v_and_b32_dpp v49, v12, v5 row_newbcast:1 row_mask:0xf bank_mask:0xf
  v_and_b32_dpp v50, v12, v6 row_newbcast:1 row_mask:0xf bank_mask:0xf
  v_and_b32_dpp v51, v12, v7 row_newbcast:1 row_mask:0xf bank_mask:0xf
  s_nop 1
  v_mfma_f32_16x16x32_bf16 v[52:55], v[48:51], v[116:119], v[52:55]
  v_and_b32_dpp v44, v12, v4 row_newbcast:2 row_mask:0xf bank_mask:0xf
  v_and_b32_dpp v45, v12, v5 row_newbcast:2 row_mask:0xf bank_mask:0xf
  v_and_b32_dpp v46, v12, v6 row_newbcast:2 row_mask:0xf bank_mask:0xf
  v_and_b32_dpp v47, v12, v7 row_newbcast:2 row_mask:0xf bank_mask:0xf
  s_nop 1
  v_mfma_f32_16x16x32_bf16 v[52:55], v[44:47], v[120:123], v[52:55]
  v_and_b32_dpp v48, v12, v4 row_newbcast:3 row_mask:0xf bank_mask:0xf
  v_and_b32_dpp v49, v12, v5 row_newbcast:3 row_mask:0xf bank_mask:0xf
  v_and_b32_dpp v50, v12, v6 row_newbcast:3 row_mask:0xf bank_mask:0xf
  v_and_b32_dpp v51, v12, v7 row_newbcast:3 row_mask:0xf bank_mask:0xf
  s_nop 1
  v_mfma_f32_16x16x32_bf16 v[52:55], v[48:51], v[124:127], v[52:55]
  s_cbranch_execz DRYXO
SEG_103:
  v_and_b32_dpp v44, v13, v4 row_newbcast:0 row_mask:0xf bank_mask:0xf
  v_and_b32_dpp v45, v13, v5 row_newbcast:0 row_mask:0xf bank_mask:0xf
  v_and_b32_dpp v46, v13, v6 row_newbcast:0 row_mask:0xf bank_mask:0xf
  v_and_b32_dpp v47, v13, v7 row_newbcast:0 row_mask:0xf bank_mask:0xf
  s_nop 1
  v_mfma_f32_16x16x32_bf16 v[52:55], v[44:47], v[128:131], v[52:55]
  v_and_b32_dpp v48, v13, v4 row_newbcast:1 row_mask:0xf bank_mask:0xf
  v_and_b32_dpp v49, v13, v5 row_newbcast:1 row_mask:0xf bank_mask:0xf
  v_and_b32_dpp v50, v13, v6 row_newbcast:1 row_mask:0xf bank_mask:0xf
  v_and_b32_dpp v51, v13, v7 row_newbcast:1 row_mask:0xf bank_mask:0xf
  s_nop 1
  v_mfma_f32_16x16x32_bf16 v[52:55], v[48:51], v[132:135], v[52:55]
  v_and_b32_dpp v44, v13, v4 row_newbcast:2 row_mask:0xf bank_mask:0xf
  v_and_b32_dpp v45, v13, v5 row_newbcast:2 row_mask:0xf bank_mask:0xf
  v_and_b32_dpp v46, v13, v6 row_newbcast:2 row_mask:0xf bank_mask:0xf
  v_and_b32_dpp v47, v13, v7 row_newbcast:2 row_mask:0xf bank_mask:0xf
  s_nop 1
  v_mfma_f32_16x16x32_bf16 v[52:55], v[44:47], v[136:139], v[52:55]
  v_and_b32_dpp v48, v13, v4 row_newbcast:3 row_mask:0xf bank_mask:0xf
  v_and_b32_dpp v49, v13, v5 row_newbcast:3 row_mask:0xf bank_mask:0xf
  v_and_b32_dpp v50, v13, v6 row_newbcast:3 row_mask:0xf bank_mask:0xf
  v_and_b32_dpp v51, v13, v7 row_newbcast:3 row_mask:0xf bank_mask:0xf
  s_nop 1
  v_mfma_f32_16x16x32_bf16 v[52:55], v[48:51], v[140:143], v[52:55]
  v_and_b32_dpp v44, v14, v4 row_newbcast:0 row_mask:0xf bank_mask:0xf
  v_and_b32_dpp v45, v14, v5 row_newbcast:0 row_mask:0xf bank_mask:0xf
  v_and_b32_dpp v46, v14, v6 row_newbcast:0 row_mask:0xf bank_mask:0xf
  v_and_b32_dpp v47, v14, v7 row_newbcast:0 row_mask:0xf bank_mask:0xf
  s_nop 1
  v_mfma_f32_16x16x32_bf16 v[52:55], v[44:47], v[144:147], v[52:55]
  s_cbranch_execz DRYXO
SEG_104:
  v_and_b32_dpp v48, v14, v4 row_newbcast:1 row_mask:0xf bank_mask:0xf
  v_and_b32_dpp v49, v14, v5 row_newbcast:1 row_mask:0xf bank_mask:0xf
  v_and_b32_dpp v50, v14, v6 row_newbcast:1 row_mask:0xf bank_mask:0xf
  v_and_b32_dpp v51, v14, v7 row_newbcast:1 row_mask:0xf bank_mask:0xf
  s_nop 1
  v_mfma_f32_16x16x32_bf16 v[52:55], v[48:51], v[148:151], v[52:55]
  v_and_b32_dpp v44, v14, v4 row_newbcast:2 row_mask:0xf bank_mask:0xf
  v_and_b32_dpp v45, v14, v5 row_newbcast:2 row_mask:0xf bank_mask:0xf
  v_and_b32_dpp v46, v14, v6 row_newbcast:2 row_mask:0xf bank_mask:0xf
  v_and_b32_dpp v47, v14, v7 row_newbcast:2 row_mask:0xf bank_mask:0xf
  s_nop 1
  v_mfma_f32_16x16x32_bf16 v[52:55], v[44:47], v[152:155], v[52:55]
  v_and_b32_dpp v48, v14, v4 row_newbcast:3 row_mask:0xf bank_mask:0xf
  v_and_b32_dpp v49, v14, v5 row_newbcast:3 row_mask:0xf bank_mask:0xf
  v_and_b32_dpp v50, v14, v6 row_newbcast:3 row_mask:0xf bank_mask:0xf
  v_and_b32_dpp v51, v14, v7 row_newbcast:3 row_mask:0xf bank_mask:0xf
  s_nop 1
  v_mfma_f32_16x16x32_bf16 v[52:55], v[48:51], v[156:159], v[52:55]
  v_and_b32_dpp v44, v15, v4 row_newbcast:0 row_mask:0xf bank_mask:0xf
  v_and_b32_dpp v45, v15, v5 row_newbcast:0 row_mask:0xf bank_mask:0xf
  v_and_b32_dpp v46, v15, v6 row_newbcast:0 row_mask:0xf bank_mask:0xf
  v_and_b32_dpp v47, v15, v7 row_newbcast:0 row_mask:0xf bank_mask:0xf
  s_nop 1
  v_mfma_f32_16x16x32_bf16 v[52:55], v[44:47], v[160:163], v[52:55]
  v_and_b32_dpp v48, v15, v4 row_newbcast:1 row_mask:0xf bank_mask:0xf
  v_and_b32_dpp v49, v15, v5 row_newbcast:1 row_mask:0xf bank_mask:0xf
  v_and_b32_dpp v50, v15, v6 row_newbcast:1 row_mask:0xf bank_mask:0xf
  v_and_b32_dpp v51, v15, v7 row_newbcast:1 row_mask:0xf bank_mask:0xf
  s_nop 1
  v_mfma_f32_16x16x32_bf16 v[52:55], v[48:51], v[164:167], v[52:55]
  s_cbranch_execz DRYXO
SEG_105:
  v_and_b32_dpp v44, v15, v4 row_newbcast:2 row_mask:0xf bank_mask:0xf
  v_and_b32_dpp v45, v15, v5 row_newbcast:2 row_mask:0xf bank_mask:0xf
  v_and_b32_dpp v46, v15, v6 row_newbcast:2 row_mask:0xf bank_mask:0xf
  v_and_b32_dpp v47, v15, v7 row_newbcast:2 row_mask:0xf bank_mask:0xf
  s_nop 1
  v_mfma_f32_16x16x32_bf16 v[52:55], v[44:47], v[168:171], v[52:55]
  v_and_b32_dpp v48, v15, v4 row_newbcast:3 row_mask:0xf bank_mask:0xf
  v_and_b32_dpp v49, v15, v5 row_newbcast:3 row_mask:0xf bank_mask:0xf
  v_and_b32_dpp v50, v15, v6 row_newbcast:3 row_mask:0xf bank_mask:0xf
  v_and_b32_dpp v51, v15, v7 row_newbcast:3 row_mask:0xf bank_mask:0xf
  s_nop 1
  v_mfma_f32_16x16x32_bf16 v[52:55], v[48:51], v[172:175], v[52:55]
  s_nop 7
  ds_write_b128 v34, v[52:55] offset:0
  s_cbranch_execz DRYXO
  s_waitcnt lgkmcnt(0)
  s_barrier
SEG_106:
  ds_read_b32 v12, v35 offset:0
  ds_read_b32 v13, v35 offset:528
  s_waitcnt lgkmcnt(0)
  v_add_f32 v12, v12, v13
  s_nop 1
  v_add_f32_dpp v12, v12, v12 quad_perm:[1,0,3,2] row_mask:0xf bank_mask:0xf
  s_nop 1
  v_add_f32_dpp v12, v12, v12 quad_perm:[2,3,0,1] row_mask:0xf bank_mask:0xf
  v_cvt_pk_bf16_f32 v12, v12, v12
  s_nop 1
  v_and_b32_dpp v44, v12, v4 row_newbcast:0 row_mask:0xf bank_mask:0xf
  v_and_b32_dpp v45, v12, v5 row_newbcast:0 row_mask:0xf bank_mask:0xf
  v_and_b32_dpp v46, v12, v6 row_newbcast:0 row_mask:0xf bank_mask:0xf
  v_and_b32_dpp v47, v12, v7 row_newbcast:0 row_mask:0xf bank_mask:0xf
  s_nop 1
  v_mfma_f32_16x16x32_bf16 v[56:59], v[44:47], v[176:179], 0
  v_mfma_f32_16x16x32_bf16 v[60:63], v[44:47], v[180:183], 0
  v_mfma_f32_16x16x32_bf16 v[64:67], v[44:47], v[184:187], 0
  v_mfma_f32_16x16x32_bf16 v[68:71], v[44:47], v[188:191], 0
  v_mfma_f32_16x16x32_bf16 v[72:75], v[44:47], v[192:195], 0
  v_and_b32_dpp v48, v12, v4 row_newbcast:4 row_mask:0xf bank_mask:0xf
  v_and_b32_dpp v49, v12, v5 row_newbcast:4 row_mask:0xf bank_mask:0xf
  v_and_b32_dpp v50, v12, v6 row_newbcast:4 row_mask:0xf bank_mask:0xf
  v_and_b32_dpp v51, v12, v7 row_newbcast:4 row_mask:0xf bank_mask:0xf
  s_nop 1
  v_mfma_f32_16x16x32_bf16 v[56:59], v[48:51], v[196:199], v[56:59]
  v_mfma_f32_16x16x32_bf16 v[60:63], v[48:51], v[200:203], v[60:63]
  v_mfma_f32_16x16x32_bf16 v[64:67], v[48:51], v[204:207], v[64:67]
  v_mfma_f32_16x16x32_bf16 v[68:71], v[48:51], v[208:211], v[68:71]
  v_mfma_f32_16x16x32_bf16 v[72:75], v[48:51], v[212:215], v[72:75]
  s_cbranch_execz DRYXO
SEG_107:
  v_and_b32_dpp v44, v12, v4 row_newbcast:8 row_mask:0xf bank_mask:0xf
  v_and_b32_dpp v45, v12, v5 row_newbcast:8 row_mask:0xf bank_mask:0xf
  v_and_b32_dpp v46, v12, v6 row_newbcast:8 row_mask:0xf bank_mask:0xf
  v_and_b32_dpp v47, v12, v7 row_newbcast:8 row_mask:0xf bank_mask:0xf
  s_nop 1
  v_mfma_f32_16x16x32_bf16 v[56:59], v[44:47], v[216:219], v[56:59]
  v_mfma_f32_16x16x32_bf16 v[60:63], v[44:47], v[220:223], v[60:63]
  v_mfma_f32_16x16x32_bf16 v[64:67], v[44:47], v[224:227], v[64:67]
  v_mfma_f32_16x16x32_bf16 v[68:71], v[44:47], v[228:231], v[68:71]
  v_mfma_f32_16x16x32_bf16 v[72:75], v[44:47], v[232:235], v[72:75]
  v_and_b32_dpp v48, v12, v4 row_newbcast:12 row_mask:0xf bank_mask:0xf
  v_and_b32_dpp v49, v12, v5 row_newbcast:12 row_mask:0xf bank_mask:0xf
  v_and_b32_dpp v50, v12, v6 row_newbcast:12 row_mask:0xf bank_mask:0xf
  v_and_b32_dpp v51, v12, v7 row_newbcast:12 row_mask:0xf bank_mask:0xf
  s_nop 1
  v_mfma_f32_16x16x32_bf16 v[56:59], v[48:51], v[236:239], v[56:59]
  v_mfma_f32_16x16x32_bf16 v[60:63], v[48:51], v[240:243], v[60:63]
  v_mfma_f32_16x16x32_bf16 v[64:67], v[48:51], v[244:247], v[64:67]
  v_mfma_f32_16x16x32_bf16 v[68:71], v[48:51], v[248:251], v[68:71]
  v_mfma_f32_16x16x32_bf16 v[72:75], v[48:51], v[252:255], v[72:75]
  s_cbranch_execz DRYXO
SEG_108:
  s_mov_b32 exec_hi, 0
  s_nop 1
  ds_write_b128 v36, v[56:59] offset:11264
  ds_write_b128 v36, v[60:63] offset:11776
  ds_write_b128 v36, v[64:67] offset:12288
  ds_write_b128 v36, v[68:71] offset:12800
  ds_write_b128 v36, v[72:75] offset:13312
  s_mov_b64 exec, s[62:63]
  s_cbranch_execz DRYXO
  s_waitcnt lgkmcnt(0)
  s_barrier
SEG_109:
  s_cmp_ge_u32 s51, 5
  s_cbranch_scc1 O_NXT
  ds_read_b128 v[76:79], v37 offset:11264
  ds_read_b128 v[80:83], v37 offset:13840
  ds_read_b128 v[84:87], v37 offset:16416
  ds_read_b128 v[88:91], v37 offset:18992
  s_waitcnt lgkmcnt(2)
  v_add_f32 v76, v76, v80
  v_add_f32 v77, v77, v81
  v_add_f32 v78, v78, v82
  v_add_f32 v79, v79, v83
  s_waitcnt lgkmcnt(0)
  v_add_f32 v84, v84, v88
  v_add_f32 v85, v85, v89
  v_add_f32 v86, v86, v90
  v_add_f32 v87, v87, v91
  v_add_f32 v76, v76, v84
  v_add_f32 v77, v77, v85
  v_add_f32 v78, v78, v86
  v_add_f32 v79, v79, v87
  v_add_f32_dpp v76, v76, v76 quad_perm:[1,0,3,2] row_mask:0xf bank_mask:0xf
  v_add_f32_dpp v77, v77, v77 quad_perm:[1,0,3,2] row_mask:0xf bank_mask:0xf
  v_add_f32_dpp v78, v78, v78 quad_perm:[1,0,3,2] row_mask:0xf bank_mask:0xf
  v_add_f32_dpp v79, v79, v79 quad_perm:[1,0,3,2] row_mask:0xf bank_mask:0xf
  v_cvt_pk_bf16_f32 v80, v76, v77
  v_cvt_pk_bf16_f32 v81, v78, v79
  s_nop 0
  v_mov_b32_dpp v82, v80 quad_perm:[2,3,0,1] row_mask:0xf bank_mask:0xf
  v_mov_b32_dpp v83, v81 quad_perm:[2,3,0,1] row_mask:0xf bank_mask:0xf
  v_min_u32 v83, -2, v83
  s_bitcmp1_b32 s36, 2
  s_cbranch_scc0 O_NXT
  s_and_b32 exec_lo, s62, 0x11111111
  s_and_b32 exec_hi, s62, 0x11111111
  buffer_store_dwordx4 v[80:83], v38, s[4:7], s42 offen sc1
  s_mov_b64 exec, s[62:63]
O_NXT:
  s_cbranch_execz DRYXO
  s_bitcmp1_b32 s36, 8
  s_cbranch_scc1 BAIL
  s_branch O_LOOP
DRYXO:
  s_add_u32 s59, s59, 8
DRYNO:
  s_mov_b64 exec, 0
  s_mov_b64 s[62:63], 0
  s_cmp_eq_u32 s59, 0
  s_cbranch_scc1 SEG_87
  s_cmp_eq_u32 s59, 1
  s_cbranch_scc1 SEG_100
  s_cmp_eq_u32 s59, 2
  s_cbranch_scc1 SEG_101
  s_cmp_eq_u32 s59, 3
  s_cbranch_scc1 SEG_102
  s_cmp_eq_u32 s59, 4
  s_cbranch_scc1 SEG_103
  s_cmp_eq_u32 s59, 5
  s_cbranch_scc1 SEG_104
  s_cmp_eq_u32 s59, 6
  s_cbranch_scc1 SEG_105
  s_cmp_eq_u32 s59, 7
  s_cbranch_scc1 SEG_106
  s_cmp_eq_u32 s59, 8
  s_cbranch_scc1 SEG_107
  s_cmp_eq_u32 s59, 9
  s_cbranch_scc1 SEG_108
  s_cmp_eq_u32 s59, 10
  s_cbranch_scc1 SEG_109
  s_mov_b64 exec, -1
  s_mov_b64 s[62:63], -1
  s_mov_b32 s51, s3
  s_branch DRYDO
ROLE_A:
  s_load_dwordx2 s[12:13], s[0:1], 8
  s_mov_b32 s14, 8388608
  s_mov_b32 s15, 0x20000
  s_load_dwordx2 s[16:17], s[0:1], 40
  s_mov_b32 s18, 5242880
  s_mov_b32 s19, 0x20000
  s_sub_u32 s48, s2, 64
  s_lshr_b32 s49, s48, 6
  s_and_b32 s48, s48, 63
  s_lshl_b32 s38, s49, 20
  s_lshl_b32 s39, s48, 10
  s_add_u32 s50, s38, s39
  s_lshl_b32 s39, s3, 7
  s_add_u32 s38, s50, s39
  v_and_b32 v12, 7, v2
  v_lshrrev_b32 v13, 3, v2
  v_lshlrev_b32 v39, 16, v12
  v_lshl_add_u32 v39, v13, 6, v39
  v_lshl_add_u32 v39, v3, 4, v39
  v_add_u32 v39, s38, v39
  s_lshl_b32 s38, s49, 13
  s_lshl_b32 s39, s48, 3
  s_add_u32 s38, s38, s39
  s_add_u32 s38, s38, 2097152
  v_lshl_add_u32 v40, v2, 9, s38
  v_lshlrev_b32 v43, 4, v1
  s_waitcnt lgkmcnt(0)
  s_lshl_b32 s38, s3, 17
  s_add_u32 s50, s50, s38
  v_mov_b32 v16, -1
  v_mov_b32 v17, -1
  v_mov_b32 v18, -1
  v_mov_b32 v19, -1
  s_add_u32 s38, s50, 0
  buffer_store_dwordx4 v[16:19], v43, s[4:7], s38 offen sc1
  s_add_u32 s38, s50, 65536
  buffer_store_dwordx4 v[16:19], v43, s[4:7], s38 offen sc1
  v_mov_b32 v32, 0
  s_cmp_ge_u32 s3, 4
  s_cbranch_scc1 A_LD
A_RA:
  v_and_b32 v12, 1, v3
  v_lshrrev_b32 v13, 1, v3
  v_lshl_add_u32 v14, v13, 4, v2
  v_lshlrev_b32 v32, 15, v12
  v_lshl_add_u32 v32, v14, 4, v32
  s_lshl_b32 s38, s49, 14
  s_lshl_b32 s39, s3, 11
  s_add_u32 s38, s38, s39
  s_add_u32 s38, s38, 2129920
  v_add_u32 v32, s38, v32
  v_lshlrev_b32 v33, 4, v14
  v_lshl_add_u32 v33, v12, 3, v33
  s_mul_i32 s38, s3, 2080
  s_add_u32 s38, s38, 133120
  v_add_u32 v33, s38, v33
  v_mul_u32_u24 v34, 1040, v2
  v_lshl_add_u32 v34, v3, 8, v34
  v_add_u32 v34, 133120, v34
  v_lshlrev_b32 v36, 5, v2
  v_add_u32 v36, 149760, v36
  s_lshl_b32 s38, s3, 2
  v_add_u32 v35, s38, v36
  v_mul_u32_u24 v14, 272, v2
  v_add_u32 v14, 150272, v14
  v_lshl_add_u32 v38, v3, 4, v14
  v_lshl_add_u32 v37, v3, 3, v14
  s_lshl_b32 s38, s3, 5
  v_add_u32 v37, s38, v37
  v_lshrrev_b32 v14, 3, v2
  v_cmp_eq_u32 vcc, v13, v14
  s_nop 1
  v_cndmask_b32 v8, 0, v8, vcc
  v_cndmask_b32 v9, 0, v9, vcc
  v_cndmask_b32 v10, 0, v10, vcc
  v_cndmask_b32 v11, 0, v11, vcc
  s_cmp_ge_u32 s3, 4
  s_cbranch_scc1 A_GO
  s_mov_b32 s36, 0
  s_mov_b64 s[44:45], 0
  s_mov_b32 s59, s3
  s_mov_b32 s51, 0
  s_branch DRYNA
DRYDA:
A_LD:
  s_lshl_b32 s38, s48, 17
  s_lshl_b32 s39, s3, 14
  s_add_u32 s38, s38, s39
  s_mul_i32 s39, s3, 16640
  s_add_u32 m0, s39, 0
  s_nop 0
  buffer_load_dwordx4 v43, s[12:15], s38 offen nt lds
  s_add_u32 s38, s38, 1024
  s_add_u32 m0, s39, 1040
  s_nop 0
  buffer_load_dwordx4 v43, s[12:15], s38 offen nt lds
  s_add_u32 s38, s38, 1024
  s_add_u32 m0, s39, 2080
  s_nop 0
  buffer_load_dwordx4 v43, s[12:15], s38 offen nt lds
  s_add_u32 s38, s38, 1024
  s_add_u32 m0, s39, 3120
  s_nop 0
  buffer_load_dwordx4 v43, s[12:15], s38 offen nt lds
  s_add_u32 s38, s38, 1024
  s_add_u32 m0, s39, 4160
  s_nop 0
  buffer_load_dwordx4 v43, s[12:15], s38 offen nt lds
  s_add_u32 s38, s38, 1024
  s_add_u32 m0, s39, 5200
  s_nop 0
  buffer_load_dwordx4 v43, s[12:15], s38 offen nt lds
  s_add_u32 s38, s38, 1024
  s_add_u32 m0, s39, 6240
  s_nop 0
  buffer_load_dwordx4 v43, s[12:15], s38 offen nt lds
  s_add_u32 s38, s38, 1024
  s_add_u32 m0, s39, 7280
  s_nop 0
  buffer_load_dwordx4 v43, s[12:15], s38 offen nt lds
  s_add_u32 s38, s38, 1024
  s_add_u32 m0, s39, 8320
  s_nop 0
  buffer_load_dwordx4 v43, s[12:15], s38 offen nt lds
  s_add_u32 s38, s38, 1024
  s_add_u32 m0, s39, 9360
  s_nop 0
  buffer_load_dwordx4 v43, s[12:15], s38 offen nt lds
  s_add_u32 s38, s38, 1024
  s_add_u32 m0, s39, 10400
  s_nop 0
  buffer_load_dwordx4 v43, s[12:15], s38 offen nt lds
  s_add_u32 s38, s38, 1024
  s_add_u32 m0, s39, 11440
  s_nop 0
  buffer_load_dwordx4 v43, s[12:15], s38 offen nt lds
  s_add_u32 s38, s38, 1024
  s_add_u32 m0, s39, 12480
  s_nop 0
  buffer_load_dwordx4 v43, s[12:15], s38 offen nt lds
  s_add_u32 s38, s38, 1024
  s_add_u32 m0, s39, 13520
  s_nop 0
  buffer_load_dwordx4 v43, s[12:15], s38 offen nt lds
  s_add_u32 s38, s38, 1024
  s_add_u32 m0, s39, 14560
  s_nop 0
  buffer_load_dwordx4 v43, s[12:15], s38 offen nt lds
  s_add_u32 s38, s38, 1024
  s_add_u32 m0, s39, 15600
  s_nop 0
  buffer_load_dwordx4 v43, s[12:15], s38 offen nt lds
  s_add_u32 s38, s38, 1024
  s_cmp_ge_u32 s3, 4
  s_cbranch_scc1 A_RA
A_GO:
  s_cmp_lg_u32 s3, 0
  s_cbranch_scc1 F_110
  buffer_load_dword v29, v28, s[8:11], 0 offen
F_110:
  s_waitcnt vmcnt(0)
  s_cmp_lg_u32 s3, 0
  s_cbranch_scc1 F_111
F_112:
  v_cmp_ne_u32 vcc, 1, v29
  s_and_b64 vcc, vcc, 255
  s_cbranch_vccz F_111
  s_sub_u32 s40, s40, 1
  s_cbranch_scc1 BAIL
  s_sleep 8
  buffer_load_dword v29, v28, s[8:11], 0 offen sc1
  s_waitcnt vmcnt(0)
  s_branch F_112
F_111:
  s_barrier
  s_cmp_lg_u32 s3, 0
  s_cbranch_scc1 R_113
  s_sub_u32 s38, s2, 64
  s_lshl_b32 s38, s38, 7
  s_add_u32 s38, s38, 2113536
  v_mov_b32 v12, 0
  s_mov_b64 exec, 1
  buffer_store_dword v12, v12, s[4:7], s38 offen sc1
  s_mov_b64 exec, -1
R_113:
  v_mul_u32_u24 v12, 1040, v2
  v_lshl_add_u32 v12, v3, 8, v12
  s_mul_i32 s38, s3, 16640
  v_add_u32 v12, s38, v12
  v_bfe_u32 v13, v1, 2, 2
  v_lshl_add_u32 v13, v3, 3, v13
  v_mul_u32_u24 v13, 1040, v13
  v_and_b32 v14, 3, v1
  v_lshl_add_u32 v13, v14, 4, v13
  s_lshl_b32 s38, s3, 7
  v_add_u32 v13, s38, v13
  v_add_u32 v14, 66560, v13
  ds_read_b128 v[128:131], v12 offset:0
  ds_read_b128 v[132:135], v12 offset:16
  ds_read_b128 v[136:139], v12 offset:32
  ds_read_b128 v[140:143], v12 offset:48
  ds_read_b128 v[144:147], v12 offset:64
  ds_read_b128 v[148:151], v12 offset:80
  ds_read_b128 v[152:155], v12 offset:96
  ds_read_b128 v[156:159], v12 offset:112
  s_waitcnt lgkmcnt(0)
  ds_read_b128 v[160:163], v12 offset:128
  ds_read_b128 v[164:167], v12 offset:144
  ds_read_b128 v[168:171], v12 offset:160
  ds_read_b128 v[172:175], v12 offset:176
  ds_read_b128 v[176:179], v12 offset:192
  ds_read_b128 v[180:183], v12 offset:208
  ds_read_b128 v[184:187], v12 offset:224
  ds_read_b128 v[188:191], v12 offset:240
  s_waitcnt lgkmcnt(0)
  ds_read_b64_tr_b16 v[192:193], v13 offset:0
  ds_read_b64_tr_b16 v[194:195], v13 offset:4160
  ds_read_b64_tr_b16 v[196:197], v13 offset:8
  ds_read_b64_tr_b16 v[198:199], v13 offset:4168
  ds_read_b64_tr_b16 v[200:201], v13 offset:64
  ds_read_b64_tr_b16 v[202:203], v13 offset:4224
  ds_read_b64_tr_b16 v[204:205], v13 offset:72
  ds_read_b64_tr_b16 v[206:207], v13 offset:4232
  s_waitcnt lgkmcnt(0)
  ds_read_b64_tr_b16 v[208:209], v13 offset:33280
  ds_read_b64_tr_b16 v[210:211], v13 offset:37440
  ds_read_b64_tr_b16 v[212:213], v13 offset:33288
  ds_read_b64_tr_b16 v[214:215], v13 offset:37448
  ds_read_b64_tr_b16 v[216:217], v13 offset:33344
  ds_read_b64_tr_b16 v[218:219], v13 offset:37504
  ds_read_b64_tr_b16 v[220:221], v13 offset:33352
  ds_read_b64_tr_b16 v[222:223], v13 offset:37512
  s_waitcnt lgkmcnt(0)
  ds_read_b64_tr_b16 v[224:225], v14 offset:0
  ds_read_b64_tr_b16 v[226:227], v14 offset:4160
  ds_read_b64_tr_b16 v[228:229], v14 offset:8
  ds_read_b64_tr_b16 v[230:231], v14 offset:4168
  ds_read_b64_tr_b16 v[232:233], v14 offset:64
  ds_read_b64_tr_b16 v[234:235], v14 offset:4224
  ds_read_b64_tr_b16 v[236:237], v14 offset:72
  ds_read_b64_tr_b16 v[238:239], v14 offset:4232
  s_waitcnt lgkmcnt(0)
  ds_read_b64_tr_b16 v[240:241], v14 offset:33280
  ds_read_b64_tr_b16 v[242:243], v14 offset:37440
  ds_read_b64_tr_b16 v[244:245], v14 offset:33288
  ds_read_b64_tr_b16 v[246:247], v14 offset:37448
  ds_read_b64_tr_b16 v[248:249], v14 offset:33344
  ds_read_b64_tr_b16 v[250:251], v14 offset:37504
  ds_read_b64_tr_b16 v[252:253], v14 offset:33352
  ds_read_b64_tr_b16 v[254:255], v14 offset:37512
  s_waitcnt lgkmcnt(0)
  v_mov_b32 v16, -1
  v_mov_b32 v17, -1
  v_mov_b32 v18, -1
  v_mov_b32 v19, -1
  s_add_u32 s38, s50, 4194304
  buffer_store_dwordx4 v[16:19], v43, s[4:7], s38 offen sc1
  s_add_u32 s38, s50, 4259840
  buffer_store_dwordx4 v[16:19], v43, s[4:7], s38 offen sc1
  s_mov_b32 s52, 3170310
  s_mov_b32 s53, 0
A_LOOP:
  s_and_b32 s36, s52, 0xfff
  s_lshr_b64 s[52:53], s[52:53], 12
  s_bitcmp1_b32 s36, 1
  s_cselect_b64 s[44:45], -1, 0
  s_bitcmp1_b32 s36, 9
  s_cselect_b32 s41, 4194304, 0
  s_add_u32 s41, s41, 0
SEG_114:
  buffer_load_dwordx4 v[44:47], v32, s[4:7], s41 offen offset:0 sc1
  s_nop 0
  buffer_load_dwordx4 v[48:51], v32, s[4:7], s41 offen offset:512 sc1
  buffer_load_dwordx4 v[52:55], v32, s[4:7], s41 offen offset:1024 sc1
  buffer_load_dwordx4 v[56:59], v32, s[4:7], s41 offen offset:1536 sc1
  s_bitcmp1_b32 s36, 1
  s_cbranch_scc0 NW_116
WT_115:
  s_waitcnt vmcnt(0)
NW_116:
  v_mfma_f32_16x16x32_bf16 v[64:67], v[8:11], v[44:47], 0
  v_mfma_f32_16x16x32_bf16 v[68:71], v[8:11], v[48:51], 0
  v_max_u32 v12, v47, v51
  v_mfma_f32_16x16x32_bf16 v[72:75], v[8:11], v[52:55], 0
  v_max3_u32 v12, v12, v55, v59
  v_mfma_f32_16x16x32_bf16 v[76:79], v[8:11], v[56:59], 0
  v_cmp_eq_u32 vcc, -1, v12
  s_and_b64 vcc, vcc, s[44:45]
  s_cbranch_vccz OK_117
  s_sub_u32 s40, s40, 1
  s_cbranch_scc1 BAIL
  v_cmp_eq_u32 vcc, -1, v47
  s_cbranch_vccz SK_118
  buffer_load_dwordx4 v[44:47], v32, s[4:7], s41 offen offset:0 sc1
SK_118:
  v_cmp_eq_u32 vcc, -1, v51
  s_cbranch_vccz SK_119
  buffer_load_dwordx4 v[48:51], v32, s[4:7], s41 offen offset:512 sc1
SK_119:
  v_cmp_eq_u32 vcc, -1, v55
  s_cbranch_vccz SK_120
  buffer_load_dwordx4 v[52:55], v32, s[4:7], s41 offen offset:1024 sc1
SK_120:
  v_cmp_eq_u32 vcc, -1, v59
  s_cbranch_vccz SK_121
  buffer_load_dwordx4 v[56:59], v32, s[4:7], s41 offen offset:1536 sc1
SK_121:
  s_branch WT_115
OK_117:
  v_cvt_pk_bf16_f32 v12, v64, v65
  v_cvt_pk_bf16_f32 v13, v66, v67
  ds_write_b64 v33, v[12:13] offset:0
  v_cvt_pk_bf16_f32 v14, v68, v69
  v_cvt_pk_bf16_f32 v15, v70, v71
  ds_write_b64 v33, v[14:15] offset:512
  v_cvt_pk_bf16_f32 v16, v72, v73
  v_cvt_pk_bf16_f32 v17, v74, v75
  ds_write_b64 v33, v[16:17] offset:1040
  v_cvt_pk_bf16_f32 v18, v76, v77
  v_cvt_pk_bf16_f32 v19, v78, v79
  ds_write_b64 v33, v[18:19] offset:1552
  s_cbranch_execz DRYXA
  s_waitcnt lgkmcnt(0)
  s_barrier
SEG_122:
  ds_read_b128 v[64:67], v34 offset:0
  ds_read_b128 v[68:71], v34 offset:16
  ds_read_b128 v[72:75], v34 offset:32
  ds_read_b128 v[76:79], v34 offset:48
  ds_read_b128 v[80:83], v34 offset:64
  ds_read_b128 v[84:87], v34 offset:80
  ds_read_b128 v[88:91], v34 offset:96
  ds_read_b128 v[92:95], v34 offset:112
  ds_read_b128 v[96:99], v34 offset:128
  ds_read_b128 v[100:103], v34 offset:144
  ds_read_b128 v[104:107], v34 offset:160
  ds_read_b128 v[108:111], v34 offset:176
  s_waitcnt lgkmcnt(11)
  v_mfma_f32_16x16x32_bf16 v[44:47], v[128:131], v[64:67], 0
  ds_read_b128 v[112:115], v34 offset:192
  s_waitcnt lgkmcnt(11)
  v_mfma_f32_16x16x32_bf16 v[48:51], v[132:135], v[68:71], 0
  ds_read_b128 v[116:119], v34 offset:208
  s_waitcnt lgkmcnt(11)
  v_mfma_f32_16x16x32_bf16 v[44:47], v[136:139], v[72:75], v[44:47]
  ds_read_b128 v[120:123], v34 offset:224
  s_waitcnt lgkmcnt(11)
  v_mfma_f32_16x16x32_bf16 v[48:51], v[140:143], v[76:79], v[48:51]
  ds_read_b128 v[124:127], v34 offset:240
  s_waitcnt lgkmcnt(11)
  v_mfma_f32_16x16x32_bf16 v[44:47], v[144:147], v[80:83], v[44:47]
  s_waitcnt lgkmcnt(10)
  v_mfma_f32_16x16x32_bf16 v[48:51], v[148:151], v[84:87], v[48:51]
  s_waitcnt lgkmcnt(9)
  v_mfma_f32_16x16x32_bf16 v[44:47], v[152:155], v[88:91], v[44:47]
  s_waitcnt lgkmcnt(8)
  v_mfma_f32_16x16x32_bf16 v[48:51], v[156:159], v[92:95], v[48:51]
  s_waitcnt lgkmcnt(7)
  v_mfma_f32_16x16x32_bf16 v[44:47], v[160:163], v[96:99], v[44:47]
  s_waitcnt lgkmcnt(6)
  v_mfma_f32_16x16x32_bf16 v[48:51], v[164:167], v[100:103], v[48:51]
  s_waitcnt lgkmcnt(5)
  v_mfma_f32_16x16x32_bf16 v[44:47], v[168:171], v[104:107], v[44:47]
  s_waitcnt lgkmcnt(4)
  v_mfma_f32_16x16x32_bf16 v[48:51], v[172:175], v[108:111], v[48:51]
  s_waitcnt lgkmcnt(3)
  v_mfma_f32_16x16x32_bf16 v[44:47], v[176:179], v[112:115], v[44:47]
  s_waitcnt lgkmcnt(2)
  v_mfma_f32_16x16x32_bf16 v[48:51], v[180:183], v[116:119], v[48:51]
  s_waitcnt lgkmcnt(1)
  v_mfma_f32_16x16x32_bf16 v[44:47], v[184:187], v[120:123], v[44:47]
  s_waitcnt lgkmcnt(0)
  v_mfma_f32_16x16x32_bf16 v[48:51], v[188:191], v[124:127], v[48:51]
  s_cbranch_execz DRYXA
SEG_123:
  s_nop 6
  v_add_f32 v44, v44, v48
  v_add_f32 v45, v45, v49
  v_add_f32 v46, v46, v50
  v_add_f32 v47, v47, v51
  v_max3_f32 v12, v44, v45, v46
  v_max_f32 v12, v12, v47
  v_mov_b32 v13, v12
  s_nop 1
  v_permlane16_swap_b32 v12, v13
  v_max_f32 v12, v12, v13
  v_mov_b32 v13, v12
  s_nop 1
  v_permlane32_swap_b32 v12, v13
  v_max_f32 v12, v12, v13
  ds_write_b32 v35, v12
  s_cbranch_execz DRYXA
  s_waitcnt lgkmcnt(0)
  s_barrier
SEG_124:
  ds_read_b128 v[12:15], v36
  ds_read_b128 v[16:19], v36 offset:16
  s_waitcnt lgkmcnt(0)
  v_max3_f32 v12, v12, v13, v14
  v_max3_f32 v16, v16, v17, v18
  v_max3_f32 v12, v12, v15, v19
  v_max_f32 v41, v12, v16
  v_sub_f32 v44, v44, v41
  v_sub_f32 v45, v45, v41
  v_sub_f32 v46, v46, v41
  v_sub_f32 v47, v47, v41
  v_exp_f32 v44, v44
  v_exp_f32 v45, v45
  v_exp_f32 v46, v46
  v_exp_f32 v47, v47
  v_cvt_pk_bf16_f32 v12, v44, v45
  v_cvt_pk_bf16_f32 v13, v46, v47
  ds_write_b64 v37, v[12:13]
  v_mov_b32 v42, 0
  v_mov_b32 v96, s46
  v_mov_b32 v97, s46
  v_mov_b32 v98, s46
  v_mov_b32 v99, s46
  s_cbranch_execz DRYXA
  s_waitcnt lgkmcnt(0)
  s_barrier
SEG_125:
  ds_read_b128 v[64:67], v38 offset:0
  ds_read_b128 v[68:71], v38 offset:64
  ds_read_b128 v[72:75], v38 offset:128
  ds_read_b128 v[76:79], v38 offset:192
  s_cmp_lg_u32 s51, 0
  s_cbranch_scc1 L_126
  s_waitcnt lgkmcnt(0)
  v_mfma_f32_16x16x32_bf16 v[100:103], v[96:99], v[64:67], 0
  v_mfma_f32_16x16x32_bf16 v[100:103], v[96:99], v[68:71], v[100:103]
  v_mfma_f32_16x16x32_bf16 v[100:103], v[96:99], v[72:75], v[100:103]
  v_mfma_f32_16x16x32_bf16 v[100:103], v[96:99], v[76:79], v[100:103]
L_126:
  s_waitcnt lgkmcnt(3)
  v_mfma_f32_16x16x32_bf16 v[80:83], v[192:195], v[64:67], 0
  v_mfma_f32_16x16x32_bf16 v[84:87], v[196:199], v[64:67], 0
  v_mfma_f32_16x16x32_bf16 v[88:91], v[200:203], v[64:67], 0
  v_mfma_f32_16x16x32_bf16 v[92:95], v[204:207], v[64:67], 0
  s_waitcnt lgkmcnt(2)
  v_mfma_f32_16x16x32_bf16 v[80:83], v[208:211], v[68:71], v[80:83]
  v_mfma_f32_16x16x32_bf16 v[84:87], v[212:215], v[68:71], v[84:87]
  v_mfma_f32_16x16x32_bf16 v[88:91], v[216:219], v[68:71], v[88:91]
  v_mfma_f32_16x16x32_bf16 v[92:95], v[220:223], v[68:71], v[92:95]
  s_cmp_lg_u32 s51, 0
  s_cbranch_scc1 L_127
  s_bitcmp1_b32 s36, 2
  s_cbranch_scc0 L_127
  s_mov_b64 exec, 0xffff
  v_min_u32 v20, -2, v41
  v_mov_b32 v21, v100
  buffer_store_dwordx2 v[20:21], v40, s[4:7], s41 offen sc1
  s_mov_b64 exec, -1
L_127:
  s_waitcnt lgkmcnt(1)
  v_mfma_f32_16x16x32_bf16 v[80:83], v[224:227], v[72:75], v[80:83]
  v_mfma_f32_16x16x32_bf16 v[84:87], v[228:231], v[72:75], v[84:87]
  v_mfma_f32_16x16x32_bf16 v[88:91], v[232:235], v[72:75], v[88:91]
  v_mfma_f32_16x16x32_bf16 v[92:95], v[236:239], v[72:75], v[92:95]
  s_waitcnt lgkmcnt(0)
  v_mfma_f32_16x16x32_bf16 v[80:83], v[240:243], v[76:79], v[80:83]
  v_mfma_f32_16x16x32_bf16 v[84:87], v[244:247], v[76:79], v[84:87]
  v_mfma_f32_16x16x32_bf16 v[88:91], v[248:251], v[76:79], v[88:91]
  v_mfma_f32_16x16x32_bf16 v[92:95], v[252:255], v[76:79], v[92:95]
  s_cbranch_execz DRYXA
SEG_128:
  v_min_u32 v41, -2, v41
  s_nop 2
  v_cvt_pk_bf16_f32 v12, v80, v81
  v_cvt_pk_bf16_f32 v13, v82, v83
  v_cvt_pk_bf16_f32 v14, v84, v85
  v_cvt_pk_bf16_f32 v15, v86, v87
  v_cvt_pk_bf16_f32 v16, v88, v89
  v_cvt_pk_bf16_f32 v17, v90, v91
  v_cvt_pk_bf16_f32 v18, v92, v93
  v_cvt_pk_bf16_f32 v19, v94, v95
  v_min_u32 v15, -2, v15
  v_min_u32 v19, -2, v19
  v_mov_b32 v104, v12
  v_mov_b32 v105, v13
  v_mov_b32 v106, v14
  v_mov_b32 v107, v15
  v_mov_b32_dpp v12, v16 row_ror:8 row_mask:0xf bank_mask:0xc
  v_mov_b32_dpp v13, v17 row_ror:8 row_mask:0xf bank_mask:0xc
  v_mov_b32_dpp v14, v18 row_ror:8 row_mask:0xf bank_mask:0xc
  v_mov_b32_dpp v15, v19 row_ror:8 row_mask:0xf bank_mask:0xc
  v_mov_b32_dpp v16, v104 row_ror:8 row_mask:0xf bank_mask:0x3
  v_mov_b32_dpp v17, v105 row_ror:8 row_mask:0xf bank_mask:0x3
  v_mov_b32_dpp v18, v106 row_ror:8 row_mask:0xf bank_mask:0x3
  v_mov_b32_dpp v19, v107 row_ror:8 row_mask:0xf bank_mask:0x3
  s_add_u32 s38, s41, 524288
  s_bitcmp1_b32 s36, 2
  s_cbranch_scc0 A_NXT
  buffer_store_dwordx4 v[12:15], v39, s[4:7], s41 offen sc1
  buffer_store_dwordx4 v[16:19], v39, s[4:7], s38 offen sc1
A_NXT:
  s_cbranch_execz DRYXA
  s_bitcmp1_b32 s36, 8
  s_cbranch_scc1 BAIL
  s_branch A_LOOP
DRYXA:
  s_add_u32 s59, s59, 4
DRYNA:
  s_mov_b64 exec, 0
  s_mov_b64 s[62:63], 0
  s_cmp_eq_u32 s59, 0
  s_cbranch_scc1 SEG_114
  s_cmp_eq_u32 s59, 1
  s_cbranch_scc1 SEG_122
  s_cmp_eq_u32 s59, 2
  s_cbranch_scc1 SEG_123
  s_cmp_eq_u32 s59, 3
  s_cbranch_scc1 SEG_124
  s_cmp_eq_u32 s59, 4
  s_cbranch_scc1 SEG_125
  s_cmp_eq_u32 s59, 5
  s_cbranch_scc1 SEG_128
  s_mov_b64 exec, -1
  s_mov_b64 s[62:63], -1
  s_mov_b32 s51, s3
  s_branch DRYDA
.section .rodata,"a"
.p2align 6
.amdhsa_kernel interleave_layers__compressed_kv_cla__glu_gated_geglu__decode_kernel
  .amdhsa_next_free_vgpr 256
  .amdhsa_next_free_sgpr 102
  .amdhsa_accum_offset 256
  .amdhsa_group_segment_fixed_size 0
  .amdhsa_kernarg_size 104
  .amdhsa_user_sgpr_count 2
  .amdhsa_user_sgpr_kernarg_segment_ptr 1
  .amdhsa_system_sgpr_workgroup_id_x 1
.end_amdhsa_kernel
```
